```python
import torch

def _softmax(x, axis=-1):
    return torch.softmax(x, dim=axis)
def _gelu(x):
    return torch.nn.functional.gelu(x, approximate="tanh")
def _silu(x):
    return torch.nn.functional.silu(x)
def _sigmoid(x):
    return torch.sigmoid(x)
def _layernorm(x, axis=-1, eps=1e-5):
    m = x.mean(dim=axis, keepdim=True)
    v = x.var(dim=axis, keepdim=True, unbiased=False)
    return (x - m) / torch.sqrt(v + eps)
def _scatter_add(tgt, idx, src, axis=0):
    return tgt.clone().index_add_(axis, idx, src)
def _segment_sum(src, seg, n):
    out = torch.zeros((n,) + src.shape[1:], dtype=src.dtype)
    return out.index_add_(0, seg, src)
def _pad(x, pw):
    flat = tuple(v for pair in reversed(pw) for v in pair)
    return torch.nn.functional.pad(x, flat)

kernel_name = 'gated_mix__spectral_fnet__dense_activation_squared_relu__prompt'

def setup_inputs():

    _w = (lambda a: (lambda t: t.to(torch.bfloat16) if t.is_floating_point() else t)(torch.as_tensor(a)))
    def _A_setup():
        B, S, D = 1, 2048, 1024
        ns = torch.arange(S)[:, None] * torch.arange(S)[None, :]
        nd = torch.arange(D)[:, None] * torch.arange(D)[None, :]
        Ws_re = torch.cos(-2.0 * torch.pi * ns / S).to(float)
        Ws_im = torch.sin(-2.0 * torch.pi * ns / S).to(float)
        Wd_re = torch.cos(-2.0 * torch.pi * nd / D).to(float)
        Wd_im = torch.sin(-2.0 * torch.pi * nd / D).to(float)
        return {
            "x": _w((lambda *s: torch.randn(*s, dtype=torch.bfloat16) * 0.05)(B, S, D)),
            "dft_seq_re": _w(Ws_re),
            "dft_seq_im": _w(Ws_im),
            "dft_hid_re": _w(Wd_re),
            "dft_hid_im": _w(Wd_im),
        }
    _A_in = _A_setup()

    def _B_setup():
        B, S, D, F = 1, 2048, 1024, 3584
        return {
            "x": _w((lambda *s: torch.randn(*s, dtype=torch.bfloat16) * 0.05)(B, S, D)),
            "w1": _w((lambda *s: torch.randn(*s, dtype=torch.bfloat16) * 0.4)(D, F)),
            "b1": _w((lambda *s: torch.randn(*s, dtype=torch.bfloat16) * 0.4)(F)),
            "w2": _w((lambda *s: torch.randn(*s, dtype=torch.bfloat16) * 0.4)(F, D)),
            "b2": _w((lambda *s: torch.randn(*s, dtype=torch.bfloat16) * 12.8)(D)),
        }
    _B_in = _B_setup()

    return {
        "A_x": _A_in["x"],
        "A_dft_seq_re": _A_in["dft_seq_re"],
        "A_dft_seq_im": _A_in["dft_seq_im"],
        "A_dft_hid_re": _A_in["dft_hid_re"],
        "A_dft_hid_im": _A_in["dft_hid_im"],
        "B_x": _B_in["x"],
        "B_w1": _B_in["w1"],
        "B_b1": _B_in["b1"],
        "B_w2": _B_in["w2"],
        "B_b2": _B_in["b2"],
        "gate_w": _w((lambda *s: torch.randn(*s, dtype=torch.bfloat16) * 0.05)(1024) * 16.0),
    }

def reference(A_x, A_dft_seq_re, A_dft_seq_im, A_dft_hid_re, A_dft_hid_im, B_x, B_w1, B_b1, B_w2, B_b2, gate_w):
    def _A_ref(x, dft_seq_re, dft_seq_im, dft_hid_re, dft_hid_im):
        a = torch.einsum("bsd,ed->bse", x, dft_hid_re)
        b = torch.einsum("bsd,ed->bse", x, dft_hid_im)
        y = torch.einsum("ts,bse->bte", dft_seq_re, a) - torch.einsum("ts,bse->bte", dft_seq_im, b)
        return y

    def _B_ref(x, w1, b1, w2, b2):
        h = torch.einsum("bsd,df->bsf", x, w1) + b1
        zero = torch.zeros_like(h)
        r = torch.where(h > zero, h, zero)
        h = r * r
        out = torch.einsum("bsf,fd->bsd", h, w2) + b2
        return out

    x = A_x
    g = _sigmoid((x * gate_w).sum(-1, keepdims=True))
    a = _A_ref(x, A_dft_seq_re, A_dft_seq_im, A_dft_hid_re, A_dft_hid_im)
    b = _B_ref(x, B_w1, B_b1, B_w2, B_b2)
    return g * a + (1 - g) * b
```

```asm
; @launch kernel=f_kernel grid=(256,1,1) block=(512,1,1) lds=163840
.amdgcn_target "amdgcn-amd-amdhsa--gfx950"
.text
.globl f_kernel
.p2align 8
.type f_kernel,@function
f_kernel:
    s_cmp_ge_u32 s2, 256
    s_cbranch_scc1 p1_end
    v_and_b32 v1, 63, v0
    v_lshrrev_b32 v2, 6, v0
    s_nop 0
    v_readfirstlane_b32 s45, v2
    s_cmp_ge_u32 s2, 224
    s_cbranch_scc1 aw_entry
    s_load_dwordx2 s[4:5], s[0:1], 0
    s_load_dwordx4 s[20:23], s[0:1], 48
    s_load_dwordx2 s[24:25], s[0:1], 104
    s_load_dwordx2 s[36:37], s[0:1], 64
    s_load_dwordx2 s[38:39], s[0:1], 80
    s_load_dwordx2 s[62:63], s[0:1], 96
    s_and_b32 s26, s2, 7
    s_lshr_b32 s27, s2, 3
    s_mul_i32 s28, s27, 37
    s_lshr_b32 s28, s28, 8
    s_mul_i32 s29, s28, 7
    s_sub_u32 s27, s27, s29
    s_lshr_b32 s29, s26, 2
    s_and_b32 s26, s26, 3
    s_lshl_b32 s29, s29, 2
    s_add_u32 s28, s28, s29
    s_mul_i32 s26, s26, 7
    s_add_u32 s29, s26, s27
    s_mul_i32 s40, s28, 524288
    s_mul_i32 s41, s29, 256
    s_mov_b32 s10, 4194304
    s_mov_b32 s11, 0x00020000
    s_mov_b32 s14, 7340032
    s_mov_b32 s15, 0x00020000
    s_cmp_ge_u32 s45, 4
    s_cbranch_scc0 p1_compute
    s_sub_u32 s45, s45, 4
    v_lshrrev_b32 v40, 3, v1
    v_lshrrev_b32 v41, 4, v1
    v_and_b32 v42, 7, v1
    v_mul_u32_u24 v43, 2048, v40
    v_xor_b32 v42, v42, v41
    v_lshl_add_u32 v43, v42, 4, v43
    v_xor_b32 v44, 64, v43
    s_mul_i32 s46, s45, 2
    s_add_u32 s46, s46, 0
    s_mul_i32 s46, s46, 65536
    v_add_u32 v2, 0, v43
    v_add_u32 v2, s46, v2
    v_add_u32 v3, 15360, v44
    v_add_u32 v3, s46, v3
    v_add_u32 v4, 30720, v43
    v_add_u32 v4, s46, v4
    v_add_u32 v5, 46080, v44
    v_add_u32 v5, s46, v5
    s_mul_i32 s46, s45, 2
    s_add_u32 s46, s46, 1
    s_mul_i32 s46, s46, 65536
    v_add_u32 v6, 0, v43
    v_add_u32 v6, s46, v6
    v_add_u32 v7, 15360, v44
    v_add_u32 v7, s46, v7
    v_add_u32 v8, 30720, v43
    v_add_u32 v8, s46, v8
    v_add_u32 v9, 46080, v44
    v_add_u32 v9, s46, v9
    s_mul_i32 s46, s45, 114688
    v_and_b32 v42, 15, v1
    v_lshlrev_b32 v45, 2, v41
    v_xor_b32 v42, v42, v45
    v_mul_u32_u24 v43, 7168, v41
    v_add_u32 v43, s46, v43
    v_lshl_add_u32 v43, v42, 4, v43
    v_xor_b32 v44, 32, v43
    v_add_u32 v10, 0, v43
    v_add_u32 v11, 27648, v43
    v_add_u32 v12, 55296, v44
    v_add_u32 v13, 82944, v44
    s_mul_i32 s50, s45, 8192
    s_mul_i32 s51, s45, 4096
    s_add_u32 s51, s51, 32768
    s_mov_b32 s43, 0
    s_cmp_eq_u32 s45, 0
    s_cselect_b32 s46, 16, 0
    s_mul_i32 s48, s2, 16
    v_add_u32 v30, s48, v1
    v_lshlrev_b32 v30, 7, v30
    v_cmp_gt_u32 vcc, s46, v1
    v_mov_b32 v46, 0x7ffffff0
    s_nop 0
    v_cndmask_b32 v30, v46, v30, vcc
    s_waitcnt lgkmcnt(0)
    s_mov_b32 s8, s4
    s_and_b32 s9, s5, 0xffff
    s_mov_b32 s12, s20
    s_and_b32 s13, s21, 0xffff
    s_mov_b32 s60, 458752
    s_mov_b32 s34, 0
    s_mov_b32 s35, 0
    s_mov_b32 s88, s62
    s_and_b32 s89, s63, 0xffff
    s_mov_b32 s90, 256
    s_mov_b32 s91, 0x00020000
    s_cmp_eq_u32 s2, 0
    s_cbranch_scc0 p1_nn
    s_cmp_eq_u32 s45, 3
    s_cbranch_scc0 p1_nn
    s_memrealtime s[58:59]
    s_waitcnt lgkmcnt(0)
    s_or_b32 s58, s58, 1
    v_mov_b32 v26, 0
    v_mov_b32 v27, s58
    buffer_store_dword v27, v26, s[88:91], 0 offen sc1
p1_nn:
    s_add_u32 m0, s43, s50
    s_nop 0
    buffer_load_dwordx4 v2, s[8:11], s40 offen offset:0 lds
    buffer_load_dwordx4 v3, s[8:11], s40 offen offset:1024 lds
    buffer_load_dwordx4 v4, s[8:11], s40 offen offset:2048 lds
    buffer_load_dwordx4 v5, s[8:11], s40 offen offset:3072 lds
    s_add_u32 m0, m0, 4096
    s_nop 0
    buffer_load_dwordx4 v6, s[8:11], s40 offen offset:0 lds
    buffer_load_dwordx4 v7, s[8:11], s40 offen offset:1024 lds
    buffer_load_dwordx4 v8, s[8:11], s40 offen offset:2048 lds
    buffer_load_dwordx4 v9, s[8:11], s40 offen offset:3072 lds
    s_add_u32 m0, s43, s51
    s_nop 0
    buffer_load_dwordx4 v10, s[12:15], s41 offen offset:0 lds
    buffer_load_dwordx4 v11, s[12:15], s41 offen offset:1024 lds
    buffer_load_dwordx4 v12, s[12:15], s41 offen offset:2048 lds
    buffer_load_dwordx4 v13, s[12:15], s41 offen offset:3072 lds
    s_add_u32 s40, s40, 128
    s_add_u32 s41, s41, 458752
    s_add_u32 s43, s43, 49152
    s_cmp_ge_u32 s43, 147456
    s_cselect_b32 s43, 0, s43
    s_add_u32 m0, s43, s50
    s_nop 0
    buffer_load_dwordx4 v2, s[8:11], s40 offen offset:0 lds
    buffer_load_dwordx4 v3, s[8:11], s40 offen offset:1024 lds
    buffer_load_dwordx4 v4, s[8:11], s40 offen offset:2048 lds
    buffer_load_dwordx4 v5, s[8:11], s40 offen offset:3072 lds
    s_add_u32 m0, m0, 4096
    s_nop 0
    buffer_load_dwordx4 v6, s[8:11], s40 offen offset:0 lds
    buffer_load_dwordx4 v7, s[8:11], s40 offen offset:1024 lds
    buffer_load_dwordx4 v8, s[8:11], s40 offen offset:2048 lds
    buffer_load_dwordx4 v9, s[8:11], s40 offen offset:3072 lds
    s_add_u32 m0, s43, s51
    s_nop 0
    buffer_load_dwordx4 v10, s[12:15], s41 offen offset:0 lds
    buffer_load_dwordx4 v11, s[12:15], s41 offen offset:1024 lds
    buffer_load_dwordx4 v12, s[12:15], s41 offen offset:2048 lds
    buffer_load_dwordx4 v13, s[12:15], s41 offen offset:3072 lds
    s_add_u32 s40, s40, 128
    s_add_u32 s41, s41, 458752
    s_add_u32 s43, s43, 49152
    s_cmp_ge_u32 s43, 147456
    s_cselect_b32 s43, 0, s43
    buffer_load_dword v47, v30, s[12:15], s60 offen
    s_add_u32 s60, s60, 458752
    buffer_load_dword v47, v30, s[12:15], s60 offen
    s_add_u32 s60, s60, 458752
    buffer_load_dword v47, v30, s[12:15], s60 offen
    s_add_u32 s60, s60, 458752
    s_waitcnt vmcnt(15)
    s_barrier
    s_mov_b32 s6, s24
    s_mov_b32 s7, s25
    s_add_u32 s6, s6, 35651584
    s_addc_u32 s7, s7, 0
    s_mov_b32 s92, s6
    s_and_b32 s93, s7, 0xffff
    s_mov_b32 s94, 4224
    s_mov_b32 s95, 0x00020000
    v_mov_b32 v27, 0
    buffer_load_dword v26, v27, s[88:91], 0 offen
p1_nonl:
    s_add_u32 m0, s43, s50
    s_nop 0
    buffer_load_dwordx4 v2, s[8:11], s40 offen offset:0 lds
    buffer_load_dwordx4 v3, s[8:11], s40 offen offset:1024 lds
    buffer_load_dwordx4 v4, s[8:11], s40 offen offset:2048 lds
    buffer_load_dwordx4 v5, s[8:11], s40 offen offset:3072 lds
    s_add_u32 m0, m0, 4096
    s_nop 0
    buffer_load_dwordx4 v6, s[8:11], s40 offen offset:0 lds
    buffer_load_dwordx4 v7, s[8:11], s40 offen offset:1024 lds
    buffer_load_dwordx4 v8, s[8:11], s40 offen offset:2048 lds
    buffer_load_dwordx4 v9, s[8:11], s40 offen offset:3072 lds
    s_add_u32 m0, s43, s51
    s_nop 0
    buffer_load_dwordx4 v10, s[12:15], s41 offen offset:0 lds
    buffer_load_dwordx4 v11, s[12:15], s41 offen offset:1024 lds
    buffer_load_dwordx4 v12, s[12:15], s41 offen offset:2048 lds
    buffer_load_dwordx4 v13, s[12:15], s41 offen offset:3072 lds
    s_add_u32 s40, s40, 128
    s_add_u32 s41, s41, 458752
    s_add_u32 s43, s43, 49152
    s_cmp_ge_u32 s43, 147456
    s_cselect_b32 s43, 0, s43
    buffer_load_dword v47, v30, s[12:15], s60 offen
    s_add_u32 s60, s60, 458752
    s_waitcnt vmcnt(13)
    s_barrier
    s_mov_b32 s59, 0x10000
p1_npoll:
    v_readfirstlane_b32 s58, v26
    s_sub_u32 s59, s59, 1
    s_cbranch_scc1 p1_ngo
    s_cmp_lg_u32 s58, 0
    s_cbranch_scc1 p1_ngo
    buffer_load_dword v26, v27, s[88:91], 0 offen sc1
    s_waitcnt vmcnt(0)
    s_branch p1_npoll
p1_ngo:
    s_mov_b32 s34, s58
    s_cmp_eq_u32 s45, 3
    s_cbranch_scc0 p1_nopub
    s_cmp_lt_u32 s2, 132
    s_cbranch_scc0 p1_nopub
    s_lshr_b32 s58, s2, 2
    s_lshl_b32 s58, s58, 7
    s_and_b32 s59, s2, 3
    s_lshl_b32 s59, s59, 2
    s_add_u32 s58, s58, s59
    v_mov_b32 v25, 0x7ffffff0
    v_mov_b32 v27, s58
    v_cmp_eq_u32 vcc, 0, v1
    s_nop 1
    v_cndmask_b32 v27, v25, v27, vcc
    buffer_store_dword v26, v27, s[92:95], 0 offen sc1
p1_nopub:
    s_add_u32 m0, s43, s50
    s_nop 0
    buffer_load_dwordx4 v2, s[8:11], s40 offen offset:0 lds
    buffer_load_dwordx4 v3, s[8:11], s40 offen offset:1024 lds
    buffer_load_dwordx4 v4, s[8:11], s40 offen offset:2048 lds
    buffer_load_dwordx4 v5, s[8:11], s40 offen offset:3072 lds
    s_add_u32 m0, m0, 4096
    s_nop 0
    buffer_load_dwordx4 v6, s[8:11], s40 offen offset:0 lds
    buffer_load_dwordx4 v7, s[8:11], s40 offen offset:1024 lds
    buffer_load_dwordx4 v8, s[8:11], s40 offen offset:2048 lds
    buffer_load_dwordx4 v9, s[8:11], s40 offen offset:3072 lds
    s_add_u32 m0, s43, s51
    s_nop 0
    buffer_load_dwordx4 v10, s[12:15], s41 offen offset:0 lds
    buffer_load_dwordx4 v11, s[12:15], s41 offen offset:1024 lds
    buffer_load_dwordx4 v12, s[12:15], s41 offen offset:2048 lds
    buffer_load_dwordx4 v13, s[12:15], s41 offen offset:3072 lds
    s_add_u32 s40, s40, 128
    s_add_u32 s41, s41, 458752
    s_add_u32 s43, s43, 49152
    s_cmp_ge_u32 s43, 147456
    s_cselect_b32 s43, 0, s43
    buffer_load_dword v47, v30, s[12:15], s60 offen
    s_add_u32 s60, s60, 458752
    s_mov_b32 s44, 12
p1_ld_loop:
    s_waitcnt vmcnt(14)
    s_barrier
    s_add_u32 m0, s43, s50
    s_nop 0
    buffer_load_dwordx4 v2, s[8:11], s40 offen offset:0 lds
    buffer_load_dwordx4 v3, s[8:11], s40 offen offset:1024 lds
    buffer_load_dwordx4 v4, s[8:11], s40 offen offset:2048 lds
    buffer_load_dwordx4 v5, s[8:11], s40 offen offset:3072 lds
    s_add_u32 m0, m0, 4096
    s_nop 0
    buffer_load_dwordx4 v6, s[8:11], s40 offen offset:0 lds
    buffer_load_dwordx4 v7, s[8:11], s40 offen offset:1024 lds
    buffer_load_dwordx4 v8, s[8:11], s40 offen offset:2048 lds
    buffer_load_dwordx4 v9, s[8:11], s40 offen offset:3072 lds
    s_add_u32 m0, s43, s51
    s_nop 0
    buffer_load_dwordx4 v10, s[12:15], s41 offen offset:0 lds
    buffer_load_dwordx4 v11, s[12:15], s41 offen offset:1024 lds
    buffer_load_dwordx4 v12, s[12:15], s41 offen offset:2048 lds
    buffer_load_dwordx4 v13, s[12:15], s41 offen offset:3072 lds
    s_add_u32 s40, s40, 128
    s_add_u32 s41, s41, 458752
    s_add_u32 s43, s43, 49152
    s_cmp_ge_u32 s43, 147456
    s_cselect_b32 s43, 0, s43
    buffer_load_dword v47, v30, s[12:15], s60 offen
    s_add_u32 s60, s60, 458752
    s_sub_u32 s44, s44, 1
    s_cmp_lg_u32 s44, 0
    s_cbranch_scc1 p1_ld_loop
    s_bfe_u32 s60, s2, 0x10001
    s_mul_i32 s60, s60, 3670016
    s_and_b32 s61, s2, 1
    s_lshl_b32 s61, s61, 10
    s_add_u32 s60, s60, s61
    s_lshr_b32 s61, s2, 3
    s_mul_i32 s61, s61, 131072
    s_add_u32 s60, s60, s61
    s_mul_i32 s61, s45, 32768
    s_add_u32 s60, s60, s61
    s_mov_b32 s56, s36
    s_and_b32 s57, s37, 0xffff
    s_mov_b32 s58, 7340032
    s_mov_b32 s59, 0x00020000
    v_lshrrev_b32 v46, 3, v1
    v_lshlrev_b32 v46, 11, v46
    v_and_b32 v45, 7, v1
    v_lshl_add_u32 v46, v45, 7, v46
    buffer_load_dword v47, v46, s[56:59], s60 offen
    s_add_u32 s60, s60, 16384
    buffer_load_dword v47, v46, s[56:59], s60 offen
    s_waitcnt vmcnt(16)
    s_barrier
    s_waitcnt vmcnt(3)
    s_barrier
    s_barrier
    s_mov_b32 s16, s24
    s_and_b32 s17, s25, 0xffff
    s_mov_b32 s18, 15204352
    s_mov_b32 s19, 0x00020000
    s_and_b32 s46, s45, 1
    s_mul_i32 s46, s46, 128
    s_mul_i32 s30, s28, 256
    s_add_u32 s30, s30, s46
    s_lshr_b32 s46, s45, 1
    s_mul_i32 s46, s46, 128
    s_mul_i32 s31, s29, 256
    s_add_u32 s31, s31, s46
    s_mul_i32 s46, s45, 16384
    v_lshrrev_b32 v50, 3, v1
    v_and_b32 v52, 7, v1
    v_xor_b32 v52, v52, v50
    v_lshlrev_b32 v53, 7, v50
    v_lshl_add_u32 v53, v52, 4, v53
    v_add_u32 v62, s46, v53
    v_add_u32 v50, s30, v50
    s_mov_b32 s48, 7424
    v_mul_lo_u32 v50, v50, s48
    v_and_b32 v52, 7, v1
    v_lshl_add_u32 v50, v52, 4, v50
    v_add_u32 v63, s31, v50
    s_barrier
    ds_read_b128 v[64:67], v62 offset:0
    ds_read_b128 v[68:71], v62 offset:1024
    ds_read_b128 v[72:75], v62 offset:2048
    ds_read_b128 v[76:79], v62 offset:3072
    s_mov_b32 s47, 0
    s_waitcnt lgkmcnt(3)
    buffer_store_dwordx4 v[64:67], v63, s[16:19], s47 offen sc0 sc1
    s_mov_b32 s47, 59392
    s_waitcnt lgkmcnt(2)
    buffer_store_dwordx4 v[68:71], v63, s[16:19], s47 offen sc0 sc1
    s_mov_b32 s47, 118784
    s_waitcnt lgkmcnt(1)
    buffer_store_dwordx4 v[72:75], v63, s[16:19], s47 offen sc0 sc1
    s_mov_b32 s47, 178176
    s_waitcnt lgkmcnt(0)
    buffer_store_dwordx4 v[76:79], v63, s[16:19], s47 offen sc0 sc1
    s_barrier
    ds_read_b128 v[80:83], v62 offset:4096
    ds_read_b128 v[84:87], v62 offset:5120
    ds_read_b128 v[88:91], v62 offset:6144
    ds_read_b128 v[92:95], v62 offset:7168
    s_mov_b32 s47, 237568
    s_waitcnt lgkmcnt(3)
    buffer_store_dwordx4 v[80:83], v63, s[16:19], s47 offen sc0 sc1
    s_mov_b32 s47, 296960
    s_waitcnt lgkmcnt(2)
    buffer_store_dwordx4 v[84:87], v63, s[16:19], s47 offen sc0 sc1
    s_mov_b32 s47, 356352
    s_waitcnt lgkmcnt(1)
    buffer_store_dwordx4 v[88:91], v63, s[16:19], s47 offen sc0 sc1
    s_mov_b32 s47, 415744
    s_waitcnt lgkmcnt(0)
    buffer_store_dwordx4 v[92:95], v63, s[16:19], s47 offen sc0 sc1
    s_barrier
    ds_read_b128 v[96:99], v62 offset:8192
    ds_read_b128 v[100:103], v62 offset:9216
    ds_read_b128 v[104:107], v62 offset:10240
    ds_read_b128 v[108:111], v62 offset:11264
    s_mov_b32 s47, 475136
    s_waitcnt lgkmcnt(3)
    buffer_store_dwordx4 v[96:99], v63, s[16:19], s47 offen sc0 sc1
    s_mov_b32 s47, 534528
    s_waitcnt lgkmcnt(2)
    buffer_store_dwordx4 v[100:103], v63, s[16:19], s47 offen sc0 sc1
    s_mov_b32 s47, 593920
    s_waitcnt lgkmcnt(1)
    buffer_store_dwordx4 v[104:107], v63, s[16:19], s47 offen sc0 sc1
    s_mov_b32 s47, 653312
    s_waitcnt lgkmcnt(0)
    buffer_store_dwordx4 v[108:111], v63, s[16:19], s47 offen sc0 sc1
    s_barrier
    ds_read_b128 v[112:115], v62 offset:12288
    ds_read_b128 v[116:119], v62 offset:13312
    ds_read_b128 v[120:123], v62 offset:14336
    ds_read_b128 v[124:127], v62 offset:15360
    s_mov_b32 s47, 712704
    s_waitcnt lgkmcnt(3)
    buffer_store_dwordx4 v[112:115], v63, s[16:19], s47 offen sc0 sc1
    s_mov_b32 s47, 772096
    s_waitcnt lgkmcnt(2)
    buffer_store_dwordx4 v[116:119], v63, s[16:19], s47 offen sc0 sc1
    s_mov_b32 s47, 831488
    s_waitcnt lgkmcnt(1)
    buffer_store_dwordx4 v[120:123], v63, s[16:19], s47 offen sc0 sc1
    s_mov_b32 s47, 890880
    s_waitcnt lgkmcnt(0)
    buffer_store_dwordx4 v[124:127], v63, s[16:19], s47 offen sc0 sc1
    s_lshl_b32 s58, s28, 9
    s_lshl_b32 s59, s29, 4
    s_add_u32 s58, s58, s59
    s_lshl_b32 s59, s45, 2
    s_add_u32 s58, s58, s59
    v_mov_b32 v28, s58
    v_mov_b32 v25, 0x7ffffff0
    v_cmp_eq_u32 vcc, 0, v1
    s_nop 1
    v_cndmask_b32 v28, v25, v28, vcc
    s_mov_b32 s6, s24
    s_mov_b32 s7, s25
    s_add_u32 s6, s6, 36700160
    s_addc_u32 s7, s7, 0
    s_mov_b32 s52, s6
    s_and_b32 s53, s7, 0xffff
    s_mov_b32 s54, 131072
    s_mov_b32 s55, 0x00020000
    v_mov_b32 v29, s34
    s_waitcnt vmcnt(0)
    buffer_store_dword v29, v28, s[52:55], 0 offen sc1
    s_getreg_b32 s58, hwreg(HW_REG_XCC_ID)
    s_add_u32 s58, s58, 1
    s_lshl_b32 s58, s58, 1
    s_add_u32 s58, s58, s34
    v_mov_b32 v29, s58
    s_and_b32 s59, s2, 3
    s_lshl_b32 s60, s28, 2
    s_add_u32 s60, s60, s59
    s_lshl_b32 s60, s60, 7
    s_mul_i32 s59, s59, 7
    s_sub_u32 s59, s29, s59
    s_lshl_b32 s59, s59, 4
    s_add_u32 s60, s60, s59
    s_lshl_b32 s59, s45, 2
    s_add_u32 s60, s60, s59
    s_add_u32 s60, s60, 8192
    v_mov_b32 v27, s60
    v_cmp_eq_u32 vcc, 0, v1
    s_nop 1
    v_cndmask_b32 v27, v25, v27, vcc
    buffer_store_dword v29, v27, s[52:55], 0 offen
    s_branch f_ld
p1_compute:
    s_setprio 3
    s_lshl_b32 s69, s2, 2
    s_add_u32 s69, s69, s45
    s_lshl_b32 s50, s69, 11
    s_sub_u32 s51, 2048, s69
    s_lshl_b32 s51, s51, 11
    s_sub_u32 s52, 1024, s69
    s_lshl_b32 s52, s52, 11
    s_add_u32 s53, 1024, s69
    s_lshl_b32 s53, s53, 11
    s_cmp_eq_u32 s69, 0
    s_cselect_b32 s53, 0x400000, s53
    s_cmp_eq_u32 s69, 512
    s_cselect_b32 s52, 0x400000, s52
    s_cselect_b32 s53, 0x400000, s53
    v_lshlrev_b32 v6, 4, v1
    s_mul_i32 s68, s45, 10240
    s_add_u32 s68, s68, 98304
    s_mov_b32 s14, 2048
    s_mov_b32 s15, 0x00020000
    s_and_b32 s46, s45, 1
    s_mul_i32 s46, s46, 128
    s_mul_i32 s30, s28, 256
    s_add_u32 s30, s30, s46
    s_lshr_b32 s46, s45, 1
    s_mul_i32 s46, s46, 128
    s_mul_i32 s31, s29, 256
    s_add_u32 s31, s31, s46
    v_lshrrev_b32 v8, 4, v1
    v_lshlrev_b32 v8, 3, v8
    s_waitcnt lgkmcnt(0)
    s_mov_b32 s8, s4
    s_and_b32 s9, s5, 0xffff
    s_mov_b32 s12, s38
    s_and_b32 s13, s39, 0xffff
    s_cmp_gt_u32 s69, 512
    s_cbranch_scc1 p1_skipload
    s_add_u32 m0, s68, 0
    s_nop 0
    buffer_load_dwordx4 v6, s[8:11], s50 offen lds
    buffer_load_dwordx4 v6, s[8:11], s50 offen offset:1024 lds
    s_add_u32 m0, s68, 2048
    s_nop 0
    buffer_load_dwordx4 v6, s[8:11], s51 offen lds
    buffer_load_dwordx4 v6, s[8:11], s51 offen offset:1024 lds
    s_add_u32 m0, s68, 4096
    s_nop 0
    buffer_load_dwordx4 v6, s[8:11], s52 offen lds
    buffer_load_dwordx4 v6, s[8:11], s52 offen offset:1024 lds
    s_add_u32 m0, s68, 6144
    s_nop 0
    buffer_load_dwordx4 v6, s[8:11], s53 offen lds
    buffer_load_dwordx4 v6, s[8:11], s53 offen offset:1024 lds
    s_add_u32 m0, s68, 8192
    s_nop 0
    buffer_load_dwordx4 v6, s[12:15], 0 offen lds
    buffer_load_dwordx4 v6, s[12:15], 0 offen offset:1024 lds
p1_skipload:
    s_mov_b32 s32, s22
    s_and_b32 s33, s23, 0xffff
    s_mov_b32 s34, 7168
    s_mov_b32 s35, 0x00020000
    s_mov_b32 s6, s24
    s_mov_b32 s7, s25
    s_add_u32 s6, s6, 25165824
    s_addc_u32 s7, s7, 0
    s_mov_b32 s16, s6
    s_and_b32 s17, s7, 0xffff
    s_mov_b32 s18, 2654208
    s_mov_b32 s19, 0x00020000
    s_mov_b32 s6, s24
    s_mov_b32 s7, s25
    s_add_u32 s6, s6, 20971520
    s_addc_u32 s7, s7, 0
    s_mov_b32 s40, s6
    s_and_b32 s41, s7, 0xffff
    s_mov_b32 s42, 16384
    s_mov_b32 s43, 0x00020000
    s_cmp_gt_u32 s69, 527
    s_cbranch_scc1 p1_nofold
    s_cmp_gt_u32 s69, 512
    s_cbranch_scc1 p1_zero
    buffer_load_dwordx2 v[184:185], v8, s[32:35], s31 offen offset:0
    buffer_load_dwordx2 v[186:187], v8, s[32:35], s31 offen offset:32
    buffer_load_dwordx2 v[188:189], v8, s[32:35], s31 offen offset:64
    buffer_load_dwordx2 v[190:191], v8, s[32:35], s31 offen offset:96
    v_lshlrev_b32 v2, 3, v1
    v_add_u32 v3, s68, v2
    v_sub_u32 v4, s68, v2
    s_waitcnt vmcnt(4)
    ds_read_b64 v[16:17], v3 offset:0
    ds_read_b64 v[18:19], v3 offset:1024
    ds_read_b64 v[20:21], v4 offset:2040
    ds_read_b32 v22, v4 offset:2048
    ds_read_b64 v[24:25], v4 offset:1016
    ds_read_b32 v26, v4 offset:1024
    ds_read_b64 v[28:29], v3 offset:2048
    ds_read_b64 v[30:31], v3 offset:3072
    ds_read_b64 v[32:33], v4 offset:4088
    ds_read_b32 v34, v4 offset:4096
    ds_read_b64 v[36:37], v4 offset:3064
    ds_read_b32 v38, v4 offset:3072
    ds_read_b64 v[40:41], v3 offset:4096
    ds_read_b64 v[42:43], v3 offset:5120
    ds_read_b64 v[44:45], v4 offset:6136
    ds_read_b32 v46, v4 offset:6144
    ds_read_b64 v[48:49], v4 offset:5112
    ds_read_b32 v50, v4 offset:5120
    ds_read_b64 v[52:53], v3 offset:6144
    ds_read_b64 v[54:55], v3 offset:7168
    ds_read_b64 v[56:57], v4 offset:8184
    ds_read_b32 v58, v4 offset:8192
    ds_read_b64 v[60:61], v4 offset:7160
    ds_read_b32 v62, v4 offset:7168
    ds_read_b64 v[64:65], v3 offset:8192
    ds_read_b64 v[66:67], v3 offset:9216
    ds_read_b64 v[68:69], v4 offset:10232
    ds_read_b32 v70, v4 offset:10240
    ds_read_b64 v[72:73], v4 offset:9208
    ds_read_b32 v74, v4 offset:9216
    v_cmp_eq_u32 s[54:55], 0, v1
    v_cmp_eq_u32 s[56:57], 63, v1
    s_waitcnt lgkmcnt(0)
    v_lshlrev_b32 v152, 16, v64
    v_and_b32 v153, 0xffff0000, v64
    v_lshlrev_b32 v154, 16, v65
    v_and_b32 v155, 0xffff0000, v65
    v_lshlrev_b32 v156, 16, v66
    v_and_b32 v157, 0xffff0000, v66
    v_lshlrev_b32 v158, 16, v67
    v_and_b32 v159, 0xffff0000, v67
    v_lshlrev_b32 v160, 16, v70
    v_and_b32 v161, 0xffff0000, v69
    v_lshlrev_b32 v162, 16, v69
    v_and_b32 v163, 0xffff0000, v68
    v_lshlrev_b32 v164, 16, v74
    v_and_b32 v165, 0xffff0000, v73
    v_lshlrev_b32 v166, 16, v73
    v_and_b32 v167, 0xffff0000, v72
    v_lshlrev_b32 v168, 16, v72
    v_lshlrev_b32 v169, 16, v68
    v_cndmask_b32 v168, 0, v168, s[56:57]
    v_cndmask_b32 v169, 0, v169, s[56:57]
    v_cndmask_b32 v160, v160, 0, s[54:55]
    v_lshlrev_b32 v80, 16, v16
    v_and_b32 v81, 0xffff0000, v16
    v_lshlrev_b32 v82, 16, v17
    v_and_b32 v83, 0xffff0000, v17
    v_lshlrev_b32 v84, 16, v18
    v_and_b32 v85, 0xffff0000, v18
    v_lshlrev_b32 v86, 16, v19
    v_and_b32 v87, 0xffff0000, v19
    v_lshlrev_b32 v88, 16, v22
    v_and_b32 v89, 0xffff0000, v21
    v_lshlrev_b32 v90, 16, v21
    v_and_b32 v91, 0xffff0000, v20
    v_lshlrev_b32 v92, 16, v26
    v_and_b32 v93, 0xffff0000, v25
    v_lshlrev_b32 v94, 16, v25
    v_and_b32 v95, 0xffff0000, v24
    v_lshlrev_b32 v96, 16, v24
    v_lshlrev_b32 v97, 16, v20
    v_cndmask_b32 v88, v88, 0, s[54:55]
    v_cndmask_b32 v84, v84, 0, s[54:55]
    v_lshlrev_b32 v98, 16, v28
    v_and_b32 v99, 0xffff0000, v28
    v_lshlrev_b32 v100, 16, v29
    v_and_b32 v101, 0xffff0000, v29
    v_lshlrev_b32 v102, 16, v30
    v_and_b32 v103, 0xffff0000, v30
    v_lshlrev_b32 v104, 16, v31
    v_and_b32 v105, 0xffff0000, v31
    v_lshlrev_b32 v106, 16, v34
    v_and_b32 v107, 0xffff0000, v33
    v_lshlrev_b32 v108, 16, v33
    v_and_b32 v109, 0xffff0000, v32
    v_lshlrev_b32 v110, 16, v38
    v_and_b32 v111, 0xffff0000, v37
    v_lshlrev_b32 v112, 16, v37
    v_and_b32 v113, 0xffff0000, v36
    v_lshlrev_b32 v114, 16, v36
    v_lshlrev_b32 v115, 16, v32
    v_cndmask_b32 v106, v106, 0, s[54:55]
    v_cndmask_b32 v102, v102, 0, s[54:55]
    v_lshlrev_b32 v116, 16, v40
    v_and_b32 v117, 0xffff0000, v40
    v_lshlrev_b32 v118, 16, v41
    v_and_b32 v119, 0xffff0000, v41
    v_lshlrev_b32 v120, 16, v42
    v_and_b32 v121, 0xffff0000, v42
    v_lshlrev_b32 v122, 16, v43
    v_and_b32 v123, 0xffff0000, v43
    v_lshlrev_b32 v124, 16, v46
    v_and_b32 v125, 0xffff0000, v45
    v_lshlrev_b32 v126, 16, v45
    v_and_b32 v127, 0xffff0000, v44
    v_lshlrev_b32 v128, 16, v50
    v_and_b32 v129, 0xffff0000, v49
    v_lshlrev_b32 v130, 16, v49
    v_and_b32 v131, 0xffff0000, v48
    v_lshlrev_b32 v132, 16, v48
    v_lshlrev_b32 v133, 16, v44
    v_cndmask_b32 v124, v124, 0, s[54:55]
    v_cndmask_b32 v120, v120, 0, s[54:55]
    v_lshlrev_b32 v134, 16, v52
    v_and_b32 v135, 0xffff0000, v52
    v_lshlrev_b32 v136, 16, v53
    v_and_b32 v137, 0xffff0000, v53
    v_lshlrev_b32 v138, 16, v54
    v_and_b32 v139, 0xffff0000, v54
    v_lshlrev_b32 v140, 16, v55
    v_and_b32 v141, 0xffff0000, v55
    v_lshlrev_b32 v142, 16, v58
    v_and_b32 v143, 0xffff0000, v57
    v_lshlrev_b32 v144, 16, v57
    v_and_b32 v145, 0xffff0000, v56
    v_lshlrev_b32 v146, 16, v62
    v_and_b32 v147, 0xffff0000, v61
    v_lshlrev_b32 v148, 16, v61
    v_and_b32 v149, 0xffff0000, v60
    v_lshlrev_b32 v150, 16, v60
    v_lshlrev_b32 v151, 16, v56
    v_cndmask_b32 v142, v142, 0, s[54:55]
    v_cndmask_b32 v138, v138, 0, s[54:55]
    v_pk_mul_f32 v[8:9], v[80:81], v[152:153]
    v_pk_mul_f32 v[10:11], v[98:99], v[152:153]
    v_pk_mul_f32 v[12:13], v[116:117], v[152:153]
    v_pk_mul_f32 v[14:15], v[134:135], v[152:153]
    v_pk_fma_f32 v[8:9], v[82:83], v[154:155], v[8:9]
    v_pk_fma_f32 v[10:11], v[100:101], v[154:155], v[10:11]
    v_pk_fma_f32 v[12:13], v[118:119], v[154:155], v[12:13]
    v_pk_fma_f32 v[14:15], v[136:137], v[154:155], v[14:15]
    v_pk_fma_f32 v[8:9], v[84:85], v[156:157], v[8:9]
    v_pk_fma_f32 v[10:11], v[102:103], v[156:157], v[10:11]
    v_pk_fma_f32 v[12:13], v[120:121], v[156:157], v[12:13]
    v_pk_fma_f32 v[14:15], v[138:139], v[156:157], v[14:15]
    v_pk_fma_f32 v[8:9], v[86:87], v[158:159], v[8:9]
    v_pk_fma_f32 v[10:11], v[104:105], v[158:159], v[10:11]
    v_pk_fma_f32 v[12:13], v[122:123], v[158:159], v[12:13]
    v_pk_fma_f32 v[14:15], v[140:141], v[158:159], v[14:15]
    v_pk_fma_f32 v[8:9], v[88:89], v[160:161], v[8:9]
    v_pk_fma_f32 v[10:11], v[106:107], v[160:161], v[10:11]
    v_pk_fma_f32 v[12:13], v[124:125], v[160:161], v[12:13]
    v_pk_fma_f32 v[14:15], v[142:143], v[160:161], v[14:15]
    v_pk_fma_f32 v[8:9], v[90:91], v[162:163], v[8:9]
    v_pk_fma_f32 v[10:11], v[108:109], v[162:163], v[10:11]
    v_pk_fma_f32 v[12:13], v[126:127], v[162:163], v[12:13]
    v_pk_fma_f32 v[14:15], v[144:145], v[162:163], v[14:15]
    v_pk_fma_f32 v[8:9], v[92:93], v[164:165], v[8:9]
    v_pk_fma_f32 v[10:11], v[110:111], v[164:165], v[10:11]
    v_pk_fma_f32 v[12:13], v[128:129], v[164:165], v[12:13]
    v_pk_fma_f32 v[14:15], v[146:147], v[164:165], v[14:15]
    v_pk_fma_f32 v[8:9], v[94:95], v[166:167], v[8:9]
    v_pk_fma_f32 v[10:11], v[112:113], v[166:167], v[10:11]
    v_pk_fma_f32 v[12:13], v[130:131], v[166:167], v[12:13]
    v_pk_fma_f32 v[14:15], v[148:149], v[166:167], v[14:15]
    v_pk_fma_f32 v[8:9], v[96:97], v[168:169], v[8:9]
    v_pk_fma_f32 v[10:11], v[114:115], v[168:169], v[10:11]
    v_pk_fma_f32 v[12:13], v[132:133], v[168:169], v[12:13]
    v_pk_fma_f32 v[14:15], v[150:151], v[168:169], v[14:15]
    v_add_f32 v8, v8, v9
    v_add_f32 v10, v10, v11
    v_add_f32 v12, v12, v13
    v_add_f32 v14, v14, v15
    v_pk_add_f32 v[172:173], v[80:81], v[98:99]
    v_pk_add_f32 v[174:175], v[80:81], v[98:99] neg_lo:[0,1] neg_hi:[0,1]
    v_pk_add_f32 v[176:177], v[116:117], v[134:135]
    v_pk_add_f32 v[178:179], v[116:117], v[134:135] neg_lo:[0,1] neg_hi:[0,1]
    v_pk_add_f32 v[80:81], v[172:173], v[176:177]
    v_pk_add_f32 v[98:99], v[172:173], v[176:177] neg_lo:[0,1] neg_hi:[0,1]
    v_pk_add_f32 v[116:117], v[174:175], v[178:179] neg_lo:[0,1] neg_hi:[0,1]
    v_pk_add_f32 v[134:135], v[174:175], v[178:179]
    v_pk_add_f32 v[172:173], v[82:83], v[100:101]
    v_pk_add_f32 v[174:175], v[82:83], v[100:101] neg_lo:[0,1] neg_hi:[0,1]
    v_pk_add_f32 v[176:177], v[118:119], v[136:137]
    v_pk_add_f32 v[178:179], v[118:119], v[136:137] neg_lo:[0,1] neg_hi:[0,1]
    v_pk_add_f32 v[82:83], v[172:173], v[176:177]
    v_pk_add_f32 v[100:101], v[172:173], v[176:177] neg_lo:[0,1] neg_hi:[0,1]
    v_pk_add_f32 v[118:119], v[174:175], v[178:179] neg_lo:[0,1] neg_hi:[0,1]
    v_pk_add_f32 v[136:137], v[174:175], v[178:179]
    v_pk_add_f32 v[172:173], v[84:85], v[102:103]
    v_pk_add_f32 v[174:175], v[84:85], v[102:103] neg_lo:[0,1] neg_hi:[0,1]
    v_pk_add_f32 v[176:177], v[120:121], v[138:139]
    v_pk_add_f32 v[178:179], v[120:121], v[138:139] neg_lo:[0,1] neg_hi:[0,1]
    v_pk_add_f32 v[84:85], v[172:173], v[176:177]
    v_pk_add_f32 v[102:103], v[172:173], v[176:177] neg_lo:[0,1] neg_hi:[0,1]
    v_pk_add_f32 v[120:121], v[174:175], v[178:179] neg_lo:[0,1] neg_hi:[0,1]
    v_pk_add_f32 v[138:139], v[174:175], v[178:179]
    v_pk_add_f32 v[172:173], v[86:87], v[104:105]
    v_pk_add_f32 v[174:175], v[86:87], v[104:105] neg_lo:[0,1] neg_hi:[0,1]
    v_pk_add_f32 v[176:177], v[122:123], v[140:141]
    v_pk_add_f32 v[178:179], v[122:123], v[140:141] neg_lo:[0,1] neg_hi:[0,1]
    v_pk_add_f32 v[86:87], v[172:173], v[176:177]
    v_pk_add_f32 v[104:105], v[172:173], v[176:177] neg_lo:[0,1] neg_hi:[0,1]
    v_pk_add_f32 v[122:123], v[174:175], v[178:179] neg_lo:[0,1] neg_hi:[0,1]
    v_pk_add_f32 v[140:141], v[174:175], v[178:179]
    v_pk_add_f32 v[172:173], v[88:89], v[106:107]
    v_pk_add_f32 v[174:175], v[88:89], v[106:107] neg_lo:[0,1] neg_hi:[0,1]
    v_pk_add_f32 v[176:177], v[124:125], v[142:143]
    v_pk_add_f32 v[178:179], v[124:125], v[142:143] neg_lo:[0,1] neg_hi:[0,1]
    v_pk_add_f32 v[88:89], v[172:173], v[176:177]
    v_pk_add_f32 v[106:107], v[172:173], v[176:177] neg_lo:[0,1] neg_hi:[0,1]
    v_pk_add_f32 v[124:125], v[174:175], v[178:179] neg_lo:[0,1] neg_hi:[0,1]
    v_pk_add_f32 v[142:143], v[174:175], v[178:179]
    v_pk_add_f32 v[172:173], v[90:91], v[108:109]
    v_pk_add_f32 v[174:175], v[90:91], v[108:109] neg_lo:[0,1] neg_hi:[0,1]
    v_pk_add_f32 v[176:177], v[126:127], v[144:145]
    v_pk_add_f32 v[178:179], v[126:127], v[144:145] neg_lo:[0,1] neg_hi:[0,1]
    v_pk_add_f32 v[90:91], v[172:173], v[176:177]
    v_pk_add_f32 v[108:109], v[172:173], v[176:177] neg_lo:[0,1] neg_hi:[0,1]
    v_pk_add_f32 v[126:127], v[174:175], v[178:179] neg_lo:[0,1] neg_hi:[0,1]
    v_pk_add_f32 v[144:145], v[174:175], v[178:179]
    v_pk_add_f32 v[172:173], v[92:93], v[110:111]
    v_pk_add_f32 v[174:175], v[92:93], v[110:111] neg_lo:[0,1] neg_hi:[0,1]
    v_pk_add_f32 v[176:177], v[128:129], v[146:147]
    v_pk_add_f32 v[178:179], v[128:129], v[146:147] neg_lo:[0,1] neg_hi:[0,1]
    v_pk_add_f32 v[92:93], v[172:173], v[176:177]
    v_pk_add_f32 v[110:111], v[172:173], v[176:177] neg_lo:[0,1] neg_hi:[0,1]
    v_pk_add_f32 v[128:129], v[174:175], v[178:179] neg_lo:[0,1] neg_hi:[0,1]
    v_pk_add_f32 v[146:147], v[174:175], v[178:179]
    v_pk_add_f32 v[172:173], v[94:95], v[112:113]
    v_pk_add_f32 v[174:175], v[94:95], v[112:113] neg_lo:[0,1] neg_hi:[0,1]
    v_pk_add_f32 v[176:177], v[130:131], v[148:149]
    v_pk_add_f32 v[178:179], v[130:131], v[148:149] neg_lo:[0,1] neg_hi:[0,1]
    v_pk_add_f32 v[94:95], v[172:173], v[176:177]
    v_pk_add_f32 v[112:113], v[172:173], v[176:177] neg_lo:[0,1] neg_hi:[0,1]
    v_pk_add_f32 v[130:131], v[174:175], v[178:179] neg_lo:[0,1] neg_hi:[0,1]
    v_pk_add_f32 v[148:149], v[174:175], v[178:179]
    v_pk_add_f32 v[172:173], v[96:97], v[114:115]
    v_pk_add_f32 v[174:175], v[96:97], v[114:115] neg_lo:[0,1] neg_hi:[0,1]
    v_pk_add_f32 v[176:177], v[132:133], v[150:151]
    v_pk_add_f32 v[178:179], v[132:133], v[150:151] neg_lo:[0,1] neg_hi:[0,1]
    v_pk_add_f32 v[96:97], v[172:173], v[176:177]
    v_pk_add_f32 v[114:115], v[172:173], v[176:177] neg_lo:[0,1] neg_hi:[0,1]
    v_pk_add_f32 v[132:133], v[174:175], v[178:179] neg_lo:[0,1] neg_hi:[0,1]
    v_pk_add_f32 v[150:151], v[174:175], v[178:179]
    v_pk_add_f32 v[172:173], v[80:81], v[88:89]
    v_pk_add_f32 v[174:175], v[92:93], v[84:85]
    v_pk_add_f32 v[16:17], v[172:173], v[174:175]
    v_pk_add_f32 v[22:23], v[172:173], v[174:175] neg_lo:[0,1] neg_hi:[0,1]
    v_pk_add_f32 v[172:173], v[82:83], v[90:91]
    v_pk_add_f32 v[174:175], v[94:95], v[86:87]
    v_pk_add_f32 v[18:19], v[172:173], v[174:175]
    v_pk_add_f32 v[24:25], v[172:173], v[174:175] neg_lo:[0,1] neg_hi:[0,1]
    v_add_f32 v20, v96, v97
    v_mov_b32 v26, 0
    v_pk_add_f32 v[172:173], v[98:99], v[106:107]
    v_pk_add_f32 v[174:175], v[110:111], v[102:103]
    v_pk_add_f32 v[28:29], v[172:173], v[174:175]
    v_pk_add_f32 v[34:35], v[172:173], v[174:175] neg_lo:[0,1] neg_hi:[0,1]
    v_pk_add_f32 v[172:173], v[100:101], v[108:109]
    v_pk_add_f32 v[174:175], v[112:113], v[104:105]
    v_pk_add_f32 v[30:31], v[172:173], v[174:175]
    v_pk_add_f32 v[36:37], v[172:173], v[174:175] neg_lo:[0,1] neg_hi:[0,1]
    v_add_f32 v32, v114, v115
    v_mov_b32 v38, 0
    v_pk_add_f32 v[172:173], v[116:117], v[124:125] neg_lo:[0,1] neg_hi:[0,1]
    v_pk_add_f32 v[174:175], v[128:129], v[120:121] neg_lo:[0,1] neg_hi:[0,1]
    v_pk_add_f32 v[40:41], v[172:173], v[174:175] neg_lo:[0,1] neg_hi:[0,1]
    v_pk_add_f32 v[46:47], v[172:173], v[174:175]
    v_pk_add_f32 v[172:173], v[118:119], v[126:127] neg_lo:[0,1] neg_hi:[0,1]
    v_pk_add_f32 v[174:175], v[130:131], v[122:123] neg_lo:[0,1] neg_hi:[0,1]
    v_pk_add_f32 v[42:43], v[172:173], v[174:175] neg_lo:[0,1] neg_hi:[0,1]
    v_pk_add_f32 v[48:49], v[172:173], v[174:175]
    v_mov_b32 v44, 0
    v_sub_f32 v50, v132, v133
    v_cndmask_b32 v40, v40, 0, s[54:55]
    v_cndmask_b32 v46, v46, 0, s[54:55]
    v_pk_add_f32 v[172:173], v[134:135], v[142:143] neg_lo:[0,1] neg_hi:[0,1]
    v_pk_add_f32 v[174:175], v[146:147], v[138:139] neg_lo:[0,1] neg_hi:[0,1]
    v_pk_add_f32 v[52:53], v[172:173], v[174:175] neg_lo:[0,1] neg_hi:[0,1]
    v_pk_add_f32 v[58:59], v[172:173], v[174:175]
    v_pk_add_f32 v[172:173], v[136:137], v[144:145] neg_lo:[0,1] neg_hi:[0,1]
    v_pk_add_f32 v[174:175], v[148:149], v[140:141] neg_lo:[0,1] neg_hi:[0,1]
    v_pk_add_f32 v[54:55], v[172:173], v[174:175] neg_lo:[0,1] neg_hi:[0,1]
    v_pk_add_f32 v[60:61], v[172:173], v[174:175]
    v_mov_b32 v56, 0
    v_sub_f32 v62, v150, v151
    v_cndmask_b32 v52, v52, 0, s[54:55]
    v_cndmask_b32 v58, v58, 0, s[54:55]
    s_and_b32 s58, s69, 511
    s_cmp_eq_u32 s58, 0
    s_cbranch_scc0 fm_1
    s_cmp_eq_u32 s69, 512
    s_cselect_b32 s58, 0, 1.0
    s_mov_b32 s59, 0
    s_cselect_b32 s60, 1.0, 0
    v_mul_f32 v28, s58, v28
    v_mul_f32 v29, s58, v29
    v_mul_f32 v30, s58, v30
    v_mul_f32 v31, s58, v31
    v_mul_f32 v32, s58, v32
    v_mul_f32 v34, s58, v34
    v_mul_f32 v35, s58, v35
    v_mul_f32 v36, s58, v36
    v_mul_f32 v37, s58, v37
    v_mul_f32 v38, s58, v38
    v_mul_f32 v40, s59, v40
    v_mul_f32 v41, s59, v41
    v_mul_f32 v42, s59, v42
    v_mul_f32 v43, s59, v43
    v_mul_f32 v44, s59, v44
    v_mul_f32 v46, s59, v46
    v_mul_f32 v47, s59, v47
    v_mul_f32 v48, s59, v48
    v_mul_f32 v49, s59, v49
    v_mul_f32 v50, s59, v50
    v_mul_f32 v52, s60, v52
    v_mul_f32 v53, s60, v53
    v_mul_f32 v54, s60, v54
    v_mul_f32 v55, s60, v55
    v_mul_f32 v56, s60, v56
    v_mul_f32 v58, s60, v58
    v_mul_f32 v59, s60, v59
    v_mul_f32 v60, s60, v60
    v_mul_f32 v61, s60, v61
    v_mul_f32 v62, s60, v62
fm_1:
    v_sub_f32 v9, v16, v17
    v_add_f32 v9, v9, v18
    v_sub_f32 v9, v9, v19
    v_cndmask_b32 v13, 0, v20, s[56:57]
    v_add_f32 v9, v9, v13
    v_sub_f32 v11, v28, v29
    v_add_f32 v11, v11, v30
    v_sub_f32 v11, v11, v31
    v_cndmask_b32 v13, 0, v32, s[56:57]
    v_add_f32 v11, v11, v13
    s_mul_i32 s67, s69, 576
    v_cvt_pk_bf16_f32 v172, v16, v17
    v_cvt_pk_bf16_f32 v173, v18, v19
    s_add_u32 s68, s67, 0
    buffer_store_dwordx2 v[172:173], v2, s[16:19], s68 offen sc1
    v_cvt_pk_bf16_f32 v174, v22, v23
    v_cvt_pk_bf16_f32 v175, v24, v25
    s_add_u32 s68, s67, 331776
    buffer_store_dwordx2 v[174:175], v2, s[16:19], s68 offen sc1
    v_cvt_pk_bf16_f32 v176, v28, v29
    v_cvt_pk_bf16_f32 v177, v30, v31
    s_add_u32 s68, s67, 663552
    buffer_store_dwordx2 v[176:177], v2, s[16:19], s68 offen sc1
    v_cvt_pk_bf16_f32 v178, v34, v35
    v_cvt_pk_bf16_f32 v179, v36, v37
    s_add_u32 s68, s67, 995328
    buffer_store_dwordx2 v[178:179], v2, s[16:19], s68 offen sc1
    v_cvt_pk_bf16_f32 v172, v40, v41
    v_cvt_pk_bf16_f32 v173, v42, v43
    s_add_u32 s68, s67, 1327104
    buffer_store_dwordx2 v[172:173], v2, s[16:19], s68 offen sc1
    v_cvt_pk_bf16_f32 v174, v46, v47
    v_cvt_pk_bf16_f32 v175, v48, v49
    s_add_u32 s68, s67, 1658880
    buffer_store_dwordx2 v[174:175], v2, s[16:19], s68 offen sc1
    v_cvt_pk_bf16_f32 v176, v52, v53
    v_cvt_pk_bf16_f32 v177, v54, v55
    s_add_u32 s68, s67, 1990656
    buffer_store_dwordx2 v[176:177], v2, s[16:19], s68 offen sc1
    v_cvt_pk_bf16_f32 v178, v58, v59
    v_cvt_pk_bf16_f32 v179, v60, v61
    s_add_u32 s68, s67, 2322432
    buffer_store_dwordx2 v[178:179], v2, s[16:19], s68 offen sc1
    v_add_f32_dpp v8, v8, v8 row_shr:1 row_mask:0xf bank_mask:0xf bound_ctrl:0
    v_add_f32_dpp v10, v10, v10 row_shr:1 row_mask:0xf bank_mask:0xf bound_ctrl:0
    v_add_f32_dpp v12, v12, v12 row_shr:1 row_mask:0xf bank_mask:0xf bound_ctrl:0
    v_add_f32_dpp v14, v14, v14 row_shr:1 row_mask:0xf bank_mask:0xf bound_ctrl:0
    v_add_f32_dpp v9, v9, v9 row_shr:1 row_mask:0xf bank_mask:0xf bound_ctrl:0
    v_add_f32_dpp v11, v11, v11 row_shr:1 row_mask:0xf bank_mask:0xf bound_ctrl:0
    v_add_f32_dpp v8, v8, v8 row_shr:2 row_mask:0xf bank_mask:0xf bound_ctrl:0
    v_add_f32_dpp v10, v10, v10 row_shr:2 row_mask:0xf bank_mask:0xf bound_ctrl:0
    v_add_f32_dpp v12, v12, v12 row_shr:2 row_mask:0xf bank_mask:0xf bound_ctrl:0
    v_add_f32_dpp v14, v14, v14 row_shr:2 row_mask:0xf bank_mask:0xf bound_ctrl:0
    v_add_f32_dpp v9, v9, v9 row_shr:2 row_mask:0xf bank_mask:0xf bound_ctrl:0
    v_add_f32_dpp v11, v11, v11 row_shr:2 row_mask:0xf bank_mask:0xf bound_ctrl:0
    v_add_f32_dpp v8, v8, v8 row_shr:4 row_mask:0xf bank_mask:0xf bound_ctrl:0
    v_add_f32_dpp v10, v10, v10 row_shr:4 row_mask:0xf bank_mask:0xf bound_ctrl:0
    v_add_f32_dpp v12, v12, v12 row_shr:4 row_mask:0xf bank_mask:0xf bound_ctrl:0
    v_add_f32_dpp v14, v14, v14 row_shr:4 row_mask:0xf bank_mask:0xf bound_ctrl:0
    v_add_f32_dpp v9, v9, v9 row_shr:4 row_mask:0xf bank_mask:0xf bound_ctrl:0
    v_add_f32_dpp v11, v11, v11 row_shr:4 row_mask:0xf bank_mask:0xf bound_ctrl:0
    v_add_f32_dpp v8, v8, v8 row_shr:8 row_mask:0xf bank_mask:0xf bound_ctrl:0
    v_add_f32_dpp v10, v10, v10 row_shr:8 row_mask:0xf bank_mask:0xf bound_ctrl:0
    v_add_f32_dpp v12, v12, v12 row_shr:8 row_mask:0xf bank_mask:0xf bound_ctrl:0
    v_add_f32_dpp v14, v14, v14 row_shr:8 row_mask:0xf bank_mask:0xf bound_ctrl:0
    v_add_f32_dpp v9, v9, v9 row_shr:8 row_mask:0xf bank_mask:0xf bound_ctrl:0
    v_add_f32_dpp v11, v11, v11 row_shr:8 row_mask:0xf bank_mask:0xf bound_ctrl:0
    v_add_f32_dpp v8, v8, v8 row_bcast:15 row_mask:0xa bank_mask:0xf
    v_add_f32_dpp v10, v10, v10 row_bcast:15 row_mask:0xa bank_mask:0xf
    v_add_f32_dpp v12, v12, v12 row_bcast:15 row_mask:0xa bank_mask:0xf
    v_add_f32_dpp v14, v14, v14 row_bcast:15 row_mask:0xa bank_mask:0xf
    v_add_f32_dpp v9, v9, v9 row_bcast:15 row_mask:0xa bank_mask:0xf
    v_add_f32_dpp v11, v11, v11 row_bcast:15 row_mask:0xa bank_mask:0xf
    v_add_f32_dpp v8, v8, v8 row_bcast:31 row_mask:0xc bank_mask:0xf
    v_add_f32_dpp v10, v10, v10 row_bcast:31 row_mask:0xc bank_mask:0xf
    v_add_f32_dpp v12, v12, v12 row_bcast:31 row_mask:0xc bank_mask:0xf
    v_add_f32_dpp v14, v14, v14 row_bcast:31 row_mask:0xc bank_mask:0xf
    v_add_f32_dpp v9, v9, v9 row_bcast:31 row_mask:0xc bank_mask:0xf
    v_add_f32_dpp v11, v11, v11 row_bcast:31 row_mask:0xc bank_mask:0xf
    s_nop 0
    v_readlane_b32 s61, v8, 63
    v_readlane_b32 s62, v10, 63
    v_readlane_b32 s63, v12, 63
    v_readlane_b32 s64, v14, 63
    v_readlane_b32 s65, v9, 63
    v_readlane_b32 s66, v11, 63
    v_lshrrev_b32 v6, 2, v1
    v_and_b32 v7, 3, v1
    v_mul_u32_u24 v13, 20736, v6
    v_lshlrev_b32 v13, 4, v13
    v_lshl_add_u32 v13, v7, 4, v13
    v_add_u32 v13, 512, v13
    v_cmp_gt_u32 vcc, 32, v1
    v_mov_b32 v15, 0x7ffffff0
    v_mov_b32 v176, 0
    v_cndmask_b32 v13, v15, v13, vcc
    v_readlane_b32 s68, v20, 63
    s_nop 3
    v_writelane_b32 v176, s68, 0
    v_readlane_b32 s68, v32, 63
    s_nop 3
    v_writelane_b32 v176, s68, 8
    v_readlane_b32 s68, v50, 63
    s_nop 3
    v_writelane_b32 v176, s68, 20
    v_readlane_b32 s68, v62, 63
    s_nop 3
    v_writelane_b32 v176, s68, 28
    v_writelane_b32 v176, s65, 2
    v_writelane_b32 v176, s66, 10
    v_mov_b32 v177, 0
    v_mov_b32 v178, 0
    v_mov_b32 v179, 0
    v_cvt_pk_bf16_f32 v176, v176, 0
    buffer_store_dwordx4 v[176:179], v13, s[16:19], s67 offen sc1
    v_mov_b32 v8, s61
    v_writelane_b32 v8, s62, 1
    v_writelane_b32 v8, s63, 2
    v_writelane_b32 v8, s64, 3
    v_mov_b32 v12, s50
    v_writelane_b32 v12, s51, 1
    v_writelane_b32 v12, s52, 2
    v_writelane_b32 v12, s53, 3
    v_mul_f32 v9, 0xbfb8aa3b, v8
    v_exp_f32 v9, v9
    v_lshrrev_b32 v12, 8, v12
    v_add_f32 v9, 1.0, v9
    v_rcp_f32 v10, v9
    v_cmp_gt_u32 vcc, 4, v1
    v_mov_b32 v9, 0x7ffffff0
    v_sub_f32 v11, 1.0, v10
    v_cndmask_b32 v12, v9, v12, vcc
    buffer_store_dwordx2 v[10:11], v12, s[40:43], 0 offen
    s_waitcnt vmcnt(10)
    s_branch p1_folded
p1_zero:
    buffer_load_dwordx2 v[184:185], v8, s[32:35], s31 offen offset:0
    buffer_load_dwordx2 v[186:187], v8, s[32:35], s31 offen offset:32
    buffer_load_dwordx2 v[188:189], v8, s[32:35], s31 offen offset:64
    buffer_load_dwordx2 v[190:191], v8, s[32:35], s31 offen offset:96
    v_lshlrev_b32 v2, 4, v1
    v_cmp_gt_u32 vcc, 36, v1
    v_mov_b32 v3, 0x7ffffff0
    v_mov_b32 v4, 0
    v_cndmask_b32 v2, v3, v2, vcc
    v_mov_b32 v5, 0
    v_mov_b32 v6, 0
    v_mov_b32 v7, 0
    s_mul_i32 s58, s69, 576
    s_add_u32 s59, s58, 0
    buffer_store_dwordx4 v[4:7], v2, s[16:19], s59 offen sc1
    s_add_u32 s59, s58, 331776
    buffer_store_dwordx4 v[4:7], v2, s[16:19], s59 offen sc1
    s_add_u32 s59, s58, 663552
    buffer_store_dwordx4 v[4:7], v2, s[16:19], s59 offen sc1
    s_add_u32 s59, s58, 995328
    buffer_store_dwordx4 v[4:7], v2, s[16:19], s59 offen sc1
    s_add_u32 s59, s58, 1327104
    buffer_store_dwordx4 v[4:7], v2, s[16:19], s59 offen sc1
    s_add_u32 s59, s58, 1658880
    buffer_store_dwordx4 v[4:7], v2, s[16:19], s59 offen sc1
    s_add_u32 s59, s58, 1990656
    buffer_store_dwordx4 v[4:7], v2, s[16:19], s59 offen sc1
    s_add_u32 s59, s58, 2322432
    buffer_store_dwordx4 v[4:7], v2, s[16:19], s59 offen sc1
    s_waitcnt vmcnt(8)
    s_branch p1_folded
p1_nofold:
    buffer_load_dwordx2 v[184:185], v8, s[32:35], s31 offen offset:0
    buffer_load_dwordx2 v[186:187], v8, s[32:35], s31 offen offset:32
    buffer_load_dwordx2 v[188:189], v8, s[32:35], s31 offen offset:64
    buffer_load_dwordx2 v[190:191], v8, s[32:35], s31 offen offset:96
    s_cmp_eq_u32 s45, 99
    s_cbranch_scc0 p1_nopf
    s_load_dwordx4 s[52:55], s[0:1], 8
    s_load_dwordx4 s[64:67], s[0:1], 24
    s_lshl_b32 s58, s2, 6
    v_add_u32 v4, s58, v1
    s_mov_b32 s59, 477218589
    v_mul_hi_u32 v5, v4, s59
    v_mul_u32_u24 v6, 9, v5
    v_sub_u32 v6, v4, v6
    v_lshlrev_b32 v7, 12, v5
    v_lshl_add_u32 v7, v6, 7, v7
    v_cmp_ge_u32 vcc, 1024, v5
    v_mov_b32 v9, 0x7ffffff0
    s_waitcnt lgkmcnt(0)
    v_cndmask_b32 v7, v9, v7, vcc
    s_mov_b32 s12, s52
    s_and_b32 s13, s53, 0xffff
    s_mov_b32 s14, 8388608
    s_mov_b32 s15, 0x00020000
    s_mov_b32 s16, s54
    s_and_b32 s17, s55, 0xffff
    s_mov_b32 s18, 8388608
    s_mov_b32 s19, 0x00020000
    buffer_load_dword v25, v7, s[12:15], 0 offen
    buffer_load_dword v25, v7, s[16:19], 0 offen
    s_mov_b32 s59, 858993460
    v_mul_hi_u32 v5, v4, s59
    v_mul_u32_u24 v6, 5, v5
    v_sub_u32 v6, v4, v6
    v_lshlrev_b32 v7, 11, v5
    v_lshl_add_u32 v7, v6, 7, v7
    v_cmp_ge_u32 vcc, 512, v5
    v_mov_b32 v9, 0x7ffffff0
    s_nop 0
    v_cndmask_b32 v7, v9, v7, vcc
    s_mov_b32 s12, s64
    s_and_b32 s13, s65, 0xffff
    s_mov_b32 s14, 2097152
    s_mov_b32 s15, 0x00020000
    s_mov_b32 s16, s66
    s_and_b32 s17, s67, 0xffff
    s_mov_b32 s18, 2097152
    s_mov_b32 s19, 0x00020000
    buffer_load_dword v25, v7, s[12:15], 0 offen
    buffer_load_dword v25, v7, s[16:19], 0 offen
    s_waitcnt vmcnt(4)
    s_branch p1_folded
p1_nopf:
    s_waitcnt vmcnt(0)
p1_folded:
    v_lshlrev_b32 v8, 16, v184
    v_and_b32 v9, 0xffff0000, v184
    v_lshlrev_b32 v10, 16, v185
    v_and_b32 v11, 0xffff0000, v185
    v_lshlrev_b32 v12, 16, v186
    v_and_b32 v13, 0xffff0000, v186
    v_lshlrev_b32 v14, 16, v187
    v_and_b32 v15, 0xffff0000, v187
    v_lshlrev_b32 v16, 16, v188
    v_and_b32 v17, 0xffff0000, v188
    v_lshlrev_b32 v18, 16, v189
    v_and_b32 v19, 0xffff0000, v189
    v_lshlrev_b32 v20, 16, v190
    v_and_b32 v21, 0xffff0000, v190
    v_lshlrev_b32 v22, 16, v191
    v_and_b32 v23, 0xffff0000, v191
    s_and_b32 s46, s45, 1
    s_lshr_b32 s47, s45, 1
    v_and_b32 v27, 15, v1
    s_mul_i32 s48, s46, 16384
    v_lshlrev_b32 v27, 7, v27
    v_add_u32 v27, s48, v27
    v_lshrrev_b32 v28, 4, v1
    v_bfe_u32 v29, v1, 1, 3
    v_xor_b32 v28, v28, v29
    v_xor_b32 v30, 0, v28
    v_lshl_add_u32 v2, v30, 4, v27
    v_xor_b32 v30, 4, v28
    v_lshl_add_u32 v3, v30, 4, v27
    v_bfe_u32 v27, v1, 2, 2
    v_lshrrev_b32 v28, 4, v1
    v_lshl_add_u32 v29, v28, 3, v27
    v_lshlrev_b32 v29, 8, v29
    v_add_u32 v29, 32768, v29
    v_and_b32 v30, 1, v1
    v_lshl_add_u32 v29, v30, 3, v29
    v_bfe_u32 v30, v1, 1, 1
    s_mul_i32 s48, s47, 8
    v_add_u32 v30, s48, v30
    v_lshlrev_b32 v27, 2, v27
    v_and_b32 v28, 1, v28
    v_lshlrev_b32 v28, 1, v28
    v_xor_b32 v27, v27, v28
    v_add_u32 v31, 0, v30
    v_xor_b32 v31, v31, v27
    v_lshl_add_u32 v4, v31, 4, v29
    v_add_u32 v31, 2, v30
    v_xor_b32 v31, v31, v27
    v_lshl_add_u32 v5, v31, 4, v29
    v_add_u32 v31, 4, v30
    v_xor_b32 v31, v31, v27
    v_lshl_add_u32 v6, v31, 4, v29
    v_add_u32 v31, 6, v30
    v_xor_b32 v31, v31, v27
    v_lshl_add_u32 v7, v31, 4, v29
    s_mov_b32 s52, 4294868992
    s_mov_b32 s53, 49152
    s_barrier
    ds_read_b64_tr_b16 v[32:33], v4 offset:0
    ds_read_b64_tr_b16 v[34:35], v4 offset:1024
    ds_read_b128 v[48:51], v2 offset:0
    ds_read_b128 v[52:55], v2 offset:2048
    ds_read_b128 v[56:59], v2 offset:4096
    ds_read_b128 v[60:63], v2 offset:6144
    ds_read_b128 v[64:67], v2 offset:8192
    ds_read_b128 v[68:71], v2 offset:10240
    ds_read_b128 v[72:75], v2 offset:12288
    ds_read_b128 v[76:79], v2 offset:14336
    ds_read_b64_tr_b16 v[36:37], v5 offset:0
    ds_read_b64_tr_b16 v[38:39], v5 offset:1024
    ds_read_b64_tr_b16 v[40:41], v6 offset:0
    ds_read_b64_tr_b16 v[42:43], v6 offset:1024
    ds_read_b64_tr_b16 v[44:45], v7 offset:0
    ds_read_b64_tr_b16 v[46:47], v7 offset:1024
    s_mov_b32 s44, 16
    s_mov_b32 s49, 0
    s_waitcnt lgkmcnt(0)
    v_mfma_f32_16x16x32_bf16 v[128:131], v[32:35], v[48:51], v[8:11]
    ds_read_b64_tr_b16 v[80:81], v4 offset:8192
    v_mfma_f32_16x16x32_bf16 v[132:135], v[32:35], v[52:55], v[8:11]
    ds_read_b64_tr_b16 v[82:83], v4 offset:9216
    v_mfma_f32_16x16x32_bf16 v[136:139], v[32:35], v[56:59], v[8:11]
    ds_read_b128 v[96:99], v3 offset:0
    v_mfma_f32_16x16x32_bf16 v[140:143], v[32:35], v[60:63], v[8:11]
    ds_read_b128 v[100:103], v3 offset:2048
    v_mfma_f32_16x16x32_bf16 v[144:147], v[32:35], v[64:67], v[8:11]
    ds_read_b128 v[104:107], v3 offset:4096
    v_mfma_f32_16x16x32_bf16 v[148:151], v[32:35], v[68:71], v[8:11]
    ds_read_b128 v[108:111], v3 offset:6144
    v_mfma_f32_16x16x32_bf16 v[152:155], v[32:35], v[72:75], v[8:11]
    ds_read_b128 v[112:115], v3 offset:8192
    v_mfma_f32_16x16x32_bf16 v[156:159], v[32:35], v[76:79], v[8:11]
    ds_read_b128 v[116:119], v3 offset:10240
    v_mfma_f32_16x16x32_bf16 v[160:163], v[36:39], v[48:51], v[12:15]
    ds_read_b128 v[120:123], v3 offset:12288
    v_mfma_f32_16x16x32_bf16 v[164:167], v[36:39], v[52:55], v[12:15]
    ds_read_b128 v[124:127], v3 offset:14336
    v_mfma_f32_16x16x32_bf16 v[168:171], v[36:39], v[56:59], v[12:15]
    ds_read_b64_tr_b16 v[84:85], v5 offset:8192
    v_mfma_f32_16x16x32_bf16 v[172:175], v[36:39], v[60:63], v[12:15]
    ds_read_b64_tr_b16 v[86:87], v5 offset:9216
    v_mfma_f32_16x16x32_bf16 v[176:179], v[36:39], v[64:67], v[12:15]
    ds_read_b64_tr_b16 v[88:89], v6 offset:8192
    v_mfma_f32_16x16x32_bf16 v[180:183], v[36:39], v[68:71], v[12:15]
    ds_read_b64_tr_b16 v[90:91], v6 offset:9216
    v_mfma_f32_16x16x32_bf16 v[184:187], v[36:39], v[72:75], v[12:15]
    ds_read_b64_tr_b16 v[92:93], v7 offset:8192
    v_mfma_f32_16x16x32_bf16 v[188:191], v[36:39], v[76:79], v[12:15]
    ds_read_b64_tr_b16 v[94:95], v7 offset:9216
    v_mfma_f32_16x16x32_bf16 v[192:195], v[40:43], v[48:51], v[16:19]
    v_mfma_f32_16x16x32_bf16 v[196:199], v[40:43], v[52:55], v[16:19]
    v_mfma_f32_16x16x32_bf16 v[200:203], v[40:43], v[56:59], v[16:19]
    v_mfma_f32_16x16x32_bf16 v[204:207], v[40:43], v[60:63], v[16:19]
    v_mfma_f32_16x16x32_bf16 v[208:211], v[40:43], v[64:67], v[16:19]
    v_mfma_f32_16x16x32_bf16 v[212:215], v[40:43], v[68:71], v[16:19]
    v_mfma_f32_16x16x32_bf16 v[216:219], v[40:43], v[72:75], v[16:19]
    v_mfma_f32_16x16x32_bf16 v[220:223], v[40:43], v[76:79], v[16:19]
    v_mfma_f32_16x16x32_bf16 v[224:227], v[44:47], v[48:51], v[20:23]
    v_mfma_f32_16x16x32_bf16 v[228:231], v[44:47], v[52:55], v[20:23]
    v_mfma_f32_16x16x32_bf16 v[232:235], v[44:47], v[56:59], v[20:23]
    v_mfma_f32_16x16x32_bf16 v[236:239], v[44:47], v[60:63], v[20:23]
    v_mfma_f32_16x16x32_bf16 v[240:243], v[44:47], v[64:67], v[20:23]
    v_mfma_f32_16x16x32_bf16 v[244:247], v[44:47], v[68:71], v[20:23]
    v_mfma_f32_16x16x32_bf16 v[248:251], v[44:47], v[72:75], v[20:23]
    v_mfma_f32_16x16x32_bf16 v[252:255], v[44:47], v[76:79], v[20:23]
    s_branch p1_hook
.p2align 6
p1_c_loop:
    s_waitcnt lgkmcnt(0)
    v_mfma_f32_16x16x32_bf16 v[128:131], v[32:35], v[48:51], v[128:131]
    ds_read_b64_tr_b16 v[80:81], v4 offset:8192
    v_mfma_f32_16x16x32_bf16 v[132:135], v[32:35], v[52:55], v[132:135]
    ds_read_b64_tr_b16 v[82:83], v4 offset:9216
    v_mfma_f32_16x16x32_bf16 v[136:139], v[32:35], v[56:59], v[136:139]
    ds_read_b128 v[96:99], v3 offset:0
    v_mfma_f32_16x16x32_bf16 v[140:143], v[32:35], v[60:63], v[140:143]
    ds_read_b128 v[100:103], v3 offset:2048
    v_mfma_f32_16x16x32_bf16 v[144:147], v[32:35], v[64:67], v[144:147]
    ds_read_b128 v[104:107], v3 offset:4096
    v_mfma_f32_16x16x32_bf16 v[148:151], v[32:35], v[68:71], v[148:151]
    ds_read_b128 v[108:111], v3 offset:6144
    v_mfma_f32_16x16x32_bf16 v[152:155], v[32:35], v[72:75], v[152:155]
    ds_read_b128 v[112:115], v3 offset:8192
    v_mfma_f32_16x16x32_bf16 v[156:159], v[32:35], v[76:79], v[156:159]
    ds_read_b128 v[116:119], v3 offset:10240
    v_mfma_f32_16x16x32_bf16 v[160:163], v[36:39], v[48:51], v[160:163]
    ds_read_b128 v[120:123], v3 offset:12288
    v_mfma_f32_16x16x32_bf16 v[164:167], v[36:39], v[52:55], v[164:167]
    ds_read_b128 v[124:127], v3 offset:14336
    v_mfma_f32_16x16x32_bf16 v[168:171], v[36:39], v[56:59], v[168:171]
    ds_read_b64_tr_b16 v[84:85], v5 offset:8192
    v_mfma_f32_16x16x32_bf16 v[172:175], v[36:39], v[60:63], v[172:175]
    ds_read_b64_tr_b16 v[86:87], v5 offset:9216
    v_mfma_f32_16x16x32_bf16 v[176:179], v[36:39], v[64:67], v[176:179]
    ds_read_b64_tr_b16 v[88:89], v6 offset:8192
    v_mfma_f32_16x16x32_bf16 v[180:183], v[36:39], v[68:71], v[180:183]
    ds_read_b64_tr_b16 v[90:91], v6 offset:9216
    v_mfma_f32_16x16x32_bf16 v[184:187], v[36:39], v[72:75], v[184:187]
    ds_read_b64_tr_b16 v[92:93], v7 offset:8192
    v_mfma_f32_16x16x32_bf16 v[188:191], v[36:39], v[76:79], v[188:191]
    ds_read_b64_tr_b16 v[94:95], v7 offset:9216
    v_mfma_f32_16x16x32_bf16 v[192:195], v[40:43], v[48:51], v[192:195]
    v_mfma_f32_16x16x32_bf16 v[196:199], v[40:43], v[52:55], v[196:199]
    v_mfma_f32_16x16x32_bf16 v[200:203], v[40:43], v[56:59], v[200:203]
    v_mfma_f32_16x16x32_bf16 v[204:207], v[40:43], v[60:63], v[204:207]
    v_mfma_f32_16x16x32_bf16 v[208:211], v[40:43], v[64:67], v[208:211]
    v_mfma_f32_16x16x32_bf16 v[212:215], v[40:43], v[68:71], v[212:215]
    v_mfma_f32_16x16x32_bf16 v[216:219], v[40:43], v[72:75], v[216:219]
    v_mfma_f32_16x16x32_bf16 v[220:223], v[40:43], v[76:79], v[220:223]
    v_mfma_f32_16x16x32_bf16 v[224:227], v[44:47], v[48:51], v[224:227]
    v_mfma_f32_16x16x32_bf16 v[228:231], v[44:47], v[52:55], v[228:231]
    v_mfma_f32_16x16x32_bf16 v[232:235], v[44:47], v[56:59], v[232:235]
    v_mfma_f32_16x16x32_bf16 v[236:239], v[44:47], v[60:63], v[236:239]
    v_mfma_f32_16x16x32_bf16 v[240:243], v[44:47], v[64:67], v[240:243]
    v_mfma_f32_16x16x32_bf16 v[244:247], v[44:47], v[68:71], v[244:247]
    v_mfma_f32_16x16x32_bf16 v[248:251], v[44:47], v[72:75], v[248:251]
    v_mfma_f32_16x16x32_bf16 v[252:255], v[44:47], v[76:79], v[252:255]
p1_c_mid:
    s_waitcnt lgkmcnt(0)
    s_barrier
    v_mfma_f32_16x16x32_bf16 v[128:131], v[80:83], v[96:99], v[128:131]
    s_add_u32 s49, s49, 49152
    s_cmp_ge_u32 s49, 147456
    v_mfma_f32_16x16x32_bf16 v[132:135], v[80:83], v[100:103], v[132:135]
    s_cselect_b32 s48, s52, s53
    s_cselect_b32 s49, 0, s49
    v_mfma_f32_16x16x32_bf16 v[136:139], v[80:83], v[104:107], v[136:139]
    v_add_u32 v2, s48, v2
    v_mfma_f32_16x16x32_bf16 v[140:143], v[80:83], v[108:111], v[140:143]
    v_add_u32 v3, s48, v3
    v_mfma_f32_16x16x32_bf16 v[144:147], v[80:83], v[112:115], v[144:147]
    v_add_u32 v4, s48, v4
    v_mfma_f32_16x16x32_bf16 v[148:151], v[80:83], v[116:119], v[148:151]
    v_add_u32 v5, s48, v5
    v_mfma_f32_16x16x32_bf16 v[152:155], v[80:83], v[120:123], v[152:155]
    v_add_u32 v6, s48, v6
    v_mfma_f32_16x16x32_bf16 v[156:159], v[80:83], v[124:127], v[156:159]
    v_add_u32 v7, s48, v7
    v_mfma_f32_16x16x32_bf16 v[160:163], v[84:87], v[96:99], v[160:163]
    ds_read_b64_tr_b16 v[32:33], v4 offset:0
    v_mfma_f32_16x16x32_bf16 v[164:167], v[84:87], v[100:103], v[164:167]
    ds_read_b64_tr_b16 v[34:35], v4 offset:1024
    v_mfma_f32_16x16x32_bf16 v[168:171], v[84:87], v[104:107], v[168:171]
    ds_read_b128 v[48:51], v2 offset:0
    v_mfma_f32_16x16x32_bf16 v[172:175], v[84:87], v[108:111], v[172:175]
    ds_read_b128 v[52:55], v2 offset:2048
    v_mfma_f32_16x16x32_bf16 v[176:179], v[84:87], v[112:115], v[176:179]
    ds_read_b128 v[56:59], v2 offset:4096
    v_mfma_f32_16x16x32_bf16 v[180:183], v[84:87], v[116:119], v[180:183]
    ds_read_b128 v[60:63], v2 offset:6144
    v_mfma_f32_16x16x32_bf16 v[184:187], v[84:87], v[120:123], v[184:187]
    ds_read_b128 v[64:67], v2 offset:8192
    v_mfma_f32_16x16x32_bf16 v[188:191], v[84:87], v[124:127], v[188:191]
    ds_read_b128 v[68:71], v2 offset:10240
    v_mfma_f32_16x16x32_bf16 v[192:195], v[88:91], v[96:99], v[192:195]
    ds_read_b128 v[72:75], v2 offset:12288
    v_mfma_f32_16x16x32_bf16 v[196:199], v[88:91], v[100:103], v[196:199]
    ds_read_b128 v[76:79], v2 offset:14336
    v_mfma_f32_16x16x32_bf16 v[200:203], v[88:91], v[104:107], v[200:203]
    ds_read_b64_tr_b16 v[36:37], v5 offset:0
    v_mfma_f32_16x16x32_bf16 v[204:207], v[88:91], v[108:111], v[204:207]
    ds_read_b64_tr_b16 v[38:39], v5 offset:1024
    v_mfma_f32_16x16x32_bf16 v[208:211], v[88:91], v[112:115], v[208:211]
    ds_read_b64_tr_b16 v[40:41], v6 offset:0
    v_mfma_f32_16x16x32_bf16 v[212:215], v[88:91], v[116:119], v[212:215]
    ds_read_b64_tr_b16 v[42:43], v6 offset:1024
    v_mfma_f32_16x16x32_bf16 v[216:219], v[88:91], v[120:123], v[216:219]
    ds_read_b64_tr_b16 v[44:45], v7 offset:0
    v_mfma_f32_16x16x32_bf16 v[220:223], v[88:91], v[124:127], v[220:223]
    ds_read_b64_tr_b16 v[46:47], v7 offset:1024
    v_mfma_f32_16x16x32_bf16 v[224:227], v[92:95], v[96:99], v[224:227]
    s_sub_u32 s44, s44, 1
    v_mfma_f32_16x16x32_bf16 v[228:231], v[92:95], v[100:103], v[228:231]
    s_cmp_lg_u32 s44, 0
    v_mfma_f32_16x16x32_bf16 v[232:235], v[92:95], v[104:107], v[232:235]
    v_mfma_f32_16x16x32_bf16 v[236:239], v[92:95], v[108:111], v[236:239]
    v_mfma_f32_16x16x32_bf16 v[240:243], v[92:95], v[112:115], v[240:243]
    v_mfma_f32_16x16x32_bf16 v[244:247], v[92:95], v[116:119], v[244:247]
    v_mfma_f32_16x16x32_bf16 v[248:251], v[92:95], v[120:123], v[248:251]
    v_mfma_f32_16x16x32_bf16 v[252:255], v[92:95], v[124:127], v[252:255]
    s_cbranch_scc1 p1_c_loop
    s_waitcnt lgkmcnt(0)
    s_mul_i32 s46, s45, 16384
    v_and_b32 v18, 15, v1
    v_lshlrev_b32 v19, 7, v18
    v_add_u32 v19, s46, v19
    v_bfe_u32 v24, v1, 4, 1
    v_lshl_add_u32 v19, v24, 3, v19
    v_and_b32 v18, 7, v18
    v_lshrrev_b32 v24, 5, v1
    v_add_u32 v25, 0, v24
    v_xor_b32 v25, v25, v18
    v_lshl_add_u32 v20, v25, 4, v19
    v_add_u32 v25, 2, v24
    v_xor_b32 v25, v25, v18
    v_lshl_add_u32 v21, v25, 4, v19
    v_add_u32 v25, 4, v24
    v_xor_b32 v25, v25, v18
    v_lshl_add_u32 v22, v25, 4, v19
    v_add_u32 v25, 6, v24
    v_xor_b32 v25, v25, v18
    v_lshl_add_u32 v23, v25, 4, v19
    v_max_f32 v128, 0, v128
    v_max_f32 v129, 0, v129
    v_max_f32 v130, 0, v130
    v_max_f32 v131, 0, v131
    v_pk_mul_f32 v[128:129], v[128:129], v[128:129]
    v_pk_mul_f32 v[130:131], v[130:131], v[130:131]
    v_cvt_pk_bf16_f32 v8, v128, v129
    v_cvt_pk_bf16_f32 v9, v130, v131
    ds_write_b64 v20, v[8:9] offset:0
    v_max_f32 v160, 0, v160
    v_max_f32 v161, 0, v161
    v_max_f32 v162, 0, v162
    v_max_f32 v163, 0, v163
    v_pk_mul_f32 v[160:161], v[160:161], v[160:161]
    v_pk_mul_f32 v[162:163], v[162:163], v[162:163]
    v_cvt_pk_bf16_f32 v10, v160, v161
    v_cvt_pk_bf16_f32 v11, v162, v163
    ds_write_b64 v21, v[10:11] offset:0
    v_max_f32 v192, 0, v192
    v_max_f32 v193, 0, v193
    v_max_f32 v194, 0, v194
    v_max_f32 v195, 0, v195
    v_pk_mul_f32 v[192:193], v[192:193], v[192:193]
    v_pk_mul_f32 v[194:195], v[194:195], v[194:195]
    v_cvt_pk_bf16_f32 v12, v192, v193
    v_cvt_pk_bf16_f32 v13, v194, v195
    ds_write_b64 v22, v[12:13] offset:0
    v_max_f32 v224, 0, v224
    v_max_f32 v225, 0, v225
    v_max_f32 v226, 0, v226
    v_max_f32 v227, 0, v227
    v_pk_mul_f32 v[224:225], v[224:225], v[224:225]
    v_pk_mul_f32 v[226:227], v[226:227], v[226:227]
    v_cvt_pk_bf16_f32 v14, v224, v225
    v_cvt_pk_bf16_f32 v15, v226, v227
    ds_write_b64 v23, v[14:15] offset:0
    v_max_f32 v132, 0, v132
    v_max_f32 v133, 0, v133
    v_max_f32 v134, 0, v134
    v_max_f32 v135, 0, v135
    v_pk_mul_f32 v[132:133], v[132:133], v[132:133]
    v_pk_mul_f32 v[134:135], v[134:135], v[134:135]
    v_cvt_pk_bf16_f32 v8, v132, v133
    v_cvt_pk_bf16_f32 v9, v134, v135
    ds_write_b64 v20, v[8:9] offset:2048
    v_max_f32 v164, 0, v164
    v_max_f32 v165, 0, v165
    v_max_f32 v166, 0, v166
    v_max_f32 v167, 0, v167
    v_pk_mul_f32 v[164:165], v[164:165], v[164:165]
    v_pk_mul_f32 v[166:167], v[166:167], v[166:167]
    v_cvt_pk_bf16_f32 v10, v164, v165
    v_cvt_pk_bf16_f32 v11, v166, v167
    ds_write_b64 v21, v[10:11] offset:2048
    v_max_f32 v196, 0, v196
    v_max_f32 v197, 0, v197
    v_max_f32 v198, 0, v198
    v_max_f32 v199, 0, v199
    v_pk_mul_f32 v[196:197], v[196:197], v[196:197]
    v_pk_mul_f32 v[198:199], v[198:199], v[198:199]
    v_cvt_pk_bf16_f32 v12, v196, v197
    v_cvt_pk_bf16_f32 v13, v198, v199
    ds_write_b64 v22, v[12:13] offset:2048
    v_max_f32 v228, 0, v228
    v_max_f32 v229, 0, v229
    v_max_f32 v230, 0, v230
    v_max_f32 v231, 0, v231
    v_pk_mul_f32 v[228:229], v[228:229], v[228:229]
    v_pk_mul_f32 v[230:231], v[230:231], v[230:231]
    v_cvt_pk_bf16_f32 v14, v228, v229
    v_cvt_pk_bf16_f32 v15, v230, v231
    ds_write_b64 v23, v[14:15] offset:2048
    s_waitcnt lgkmcnt(0)
    s_barrier
    v_max_f32 v136, 0, v136
    v_max_f32 v137, 0, v137
    v_max_f32 v138, 0, v138
    v_max_f32 v139, 0, v139
    v_pk_mul_f32 v[136:137], v[136:137], v[136:137]
    v_pk_mul_f32 v[138:139], v[138:139], v[138:139]
    v_cvt_pk_bf16_f32 v8, v136, v137
    v_cvt_pk_bf16_f32 v9, v138, v139
    ds_write_b64 v20, v[8:9] offset:4096
    v_max_f32 v168, 0, v168
    v_max_f32 v169, 0, v169
    v_max_f32 v170, 0, v170
    v_max_f32 v171, 0, v171
    v_pk_mul_f32 v[168:169], v[168:169], v[168:169]
    v_pk_mul_f32 v[170:171], v[170:171], v[170:171]
    v_cvt_pk_bf16_f32 v10, v168, v169
    v_cvt_pk_bf16_f32 v11, v170, v171
    ds_write_b64 v21, v[10:11] offset:4096
    v_max_f32 v200, 0, v200
    v_max_f32 v201, 0, v201
    v_max_f32 v202, 0, v202
    v_max_f32 v203, 0, v203
    v_pk_mul_f32 v[200:201], v[200:201], v[200:201]
    v_pk_mul_f32 v[202:203], v[202:203], v[202:203]
    v_cvt_pk_bf16_f32 v12, v200, v201
    v_cvt_pk_bf16_f32 v13, v202, v203
    ds_write_b64 v22, v[12:13] offset:4096
    v_max_f32 v232, 0, v232
    v_max_f32 v233, 0, v233
    v_max_f32 v234, 0, v234
    v_max_f32 v235, 0, v235
    v_pk_mul_f32 v[232:233], v[232:233], v[232:233]
    v_pk_mul_f32 v[234:235], v[234:235], v[234:235]
    v_cvt_pk_bf16_f32 v14, v232, v233
    v_cvt_pk_bf16_f32 v15, v234, v235
    ds_write_b64 v23, v[14:15] offset:4096
    v_max_f32 v140, 0, v140
    v_max_f32 v141, 0, v141
    v_max_f32 v142, 0, v142
    v_max_f32 v143, 0, v143
    v_pk_mul_f32 v[140:141], v[140:141], v[140:141]
    v_pk_mul_f32 v[142:143], v[142:143], v[142:143]
    v_cvt_pk_bf16_f32 v8, v140, v141
    v_cvt_pk_bf16_f32 v9, v142, v143
    ds_write_b64 v20, v[8:9] offset:6144
    v_max_f32 v172, 0, v172
    v_max_f32 v173, 0, v173
    v_max_f32 v174, 0, v174
    v_max_f32 v175, 0, v175
    v_pk_mul_f32 v[172:173], v[172:173], v[172:173]
    v_pk_mul_f32 v[174:175], v[174:175], v[174:175]
    v_cvt_pk_bf16_f32 v10, v172, v173
    v_cvt_pk_bf16_f32 v11, v174, v175
    ds_write_b64 v21, v[10:11] offset:6144
    v_max_f32 v204, 0, v204
    v_max_f32 v205, 0, v205
    v_max_f32 v206, 0, v206
    v_max_f32 v207, 0, v207
    v_pk_mul_f32 v[204:205], v[204:205], v[204:205]
    v_pk_mul_f32 v[206:207], v[206:207], v[206:207]
    v_cvt_pk_bf16_f32 v12, v204, v205
    v_cvt_pk_bf16_f32 v13, v206, v207
    ds_write_b64 v22, v[12:13] offset:6144
    v_max_f32 v236, 0, v236
    v_max_f32 v237, 0, v237
    v_max_f32 v238, 0, v238
    v_max_f32 v239, 0, v239
    v_pk_mul_f32 v[236:237], v[236:237], v[236:237]
    v_pk_mul_f32 v[238:239], v[238:239], v[238:239]
    v_cvt_pk_bf16_f32 v14, v236, v237
    v_cvt_pk_bf16_f32 v15, v238, v239
    ds_write_b64 v23, v[14:15] offset:6144
    s_waitcnt lgkmcnt(0)
    s_barrier
    v_max_f32 v144, 0, v144
    v_max_f32 v145, 0, v145
    v_max_f32 v146, 0, v146
    v_max_f32 v147, 0, v147
    v_pk_mul_f32 v[144:145], v[144:145], v[144:145]
    v_pk_mul_f32 v[146:147], v[146:147], v[146:147]
    v_cvt_pk_bf16_f32 v8, v144, v145
    v_cvt_pk_bf16_f32 v9, v146, v147
    ds_write_b64 v20, v[8:9] offset:8192
    v_max_f32 v176, 0, v176
    v_max_f32 v177, 0, v177
    v_max_f32 v178, 0, v178
    v_max_f32 v179, 0, v179
    v_pk_mul_f32 v[176:177], v[176:177], v[176:177]
    v_pk_mul_f32 v[178:179], v[178:179], v[178:179]
    v_cvt_pk_bf16_f32 v10, v176, v177
    v_cvt_pk_bf16_f32 v11, v178, v179
    ds_write_b64 v21, v[10:11] offset:8192
    v_max_f32 v208, 0, v208
    v_max_f32 v209, 0, v209
    v_max_f32 v210, 0, v210
    v_max_f32 v211, 0, v211
    v_pk_mul_f32 v[208:209], v[208:209], v[208:209]
    v_pk_mul_f32 v[210:211], v[210:211], v[210:211]
    v_cvt_pk_bf16_f32 v12, v208, v209
    v_cvt_pk_bf16_f32 v13, v210, v211
    ds_write_b64 v22, v[12:13] offset:8192
    v_max_f32 v240, 0, v240
    v_max_f32 v241, 0, v241
    v_max_f32 v242, 0, v242
    v_max_f32 v243, 0, v243
    v_pk_mul_f32 v[240:241], v[240:241], v[240:241]
    v_pk_mul_f32 v[242:243], v[242:243], v[242:243]
    v_cvt_pk_bf16_f32 v14, v240, v241
    v_cvt_pk_bf16_f32 v15, v242, v243
    ds_write_b64 v23, v[14:15] offset:8192
    v_max_f32 v148, 0, v148
    v_max_f32 v149, 0, v149
    v_max_f32 v150, 0, v150
    v_max_f32 v151, 0, v151
    v_pk_mul_f32 v[148:149], v[148:149], v[148:149]
    v_pk_mul_f32 v[150:151], v[150:151], v[150:151]
    v_cvt_pk_bf16_f32 v8, v148, v149
    v_cvt_pk_bf16_f32 v9, v150, v151
    ds_write_b64 v20, v[8:9] offset:10240
    v_max_f32 v180, 0, v180
    v_max_f32 v181, 0, v181
    v_max_f32 v182, 0, v182
    v_max_f32 v183, 0, v183
    v_pk_mul_f32 v[180:181], v[180:181], v[180:181]
    v_pk_mul_f32 v[182:183], v[182:183], v[182:183]
    v_cvt_pk_bf16_f32 v10, v180, v181
    v_cvt_pk_bf16_f32 v11, v182, v183
    ds_write_b64 v21, v[10:11] offset:10240
    v_max_f32 v212, 0, v212
    v_max_f32 v213, 0, v213
    v_max_f32 v214, 0, v214
    v_max_f32 v215, 0, v215
    v_pk_mul_f32 v[212:213], v[212:213], v[212:213]
    v_pk_mul_f32 v[214:215], v[214:215], v[214:215]
    v_cvt_pk_bf16_f32 v12, v212, v213
    v_cvt_pk_bf16_f32 v13, v214, v215
    ds_write_b64 v22, v[12:13] offset:10240
    v_max_f32 v244, 0, v244
    v_max_f32 v245, 0, v245
    v_max_f32 v246, 0, v246
    v_max_f32 v247, 0, v247
    v_pk_mul_f32 v[244:245], v[244:245], v[244:245]
    v_pk_mul_f32 v[246:247], v[246:247], v[246:247]
    v_cvt_pk_bf16_f32 v14, v244, v245
    v_cvt_pk_bf16_f32 v15, v246, v247
    ds_write_b64 v23, v[14:15] offset:10240
    s_waitcnt lgkmcnt(0)
    s_barrier
    v_max_f32 v152, 0, v152
    v_max_f32 v153, 0, v153
    v_max_f32 v154, 0, v154
    v_max_f32 v155, 0, v155
    v_pk_mul_f32 v[152:153], v[152:153], v[152:153]
    v_pk_mul_f32 v[154:155], v[154:155], v[154:155]
    v_cvt_pk_bf16_f32 v8, v152, v153
    v_cvt_pk_bf16_f32 v9, v154, v155
    ds_write_b64 v20, v[8:9] offset:12288
    v_max_f32 v184, 0, v184
    v_max_f32 v185, 0, v185
    v_max_f32 v186, 0, v186
    v_max_f32 v187, 0, v187
    v_pk_mul_f32 v[184:185], v[184:185], v[184:185]
    v_pk_mul_f32 v[186:187], v[186:187], v[186:187]
    v_cvt_pk_bf16_f32 v10, v184, v185
    v_cvt_pk_bf16_f32 v11, v186, v187
    ds_write_b64 v21, v[10:11] offset:12288
    v_max_f32 v216, 0, v216
    v_max_f32 v217, 0, v217
    v_max_f32 v218, 0, v218
    v_max_f32 v219, 0, v219
    v_pk_mul_f32 v[216:217], v[216:217], v[216:217]
    v_pk_mul_f32 v[218:219], v[218:219], v[218:219]
    v_cvt_pk_bf16_f32 v12, v216, v217
    v_cvt_pk_bf16_f32 v13, v218, v219
    ds_write_b64 v22, v[12:13] offset:12288
    v_max_f32 v248, 0, v248
    v_max_f32 v249, 0, v249
    v_max_f32 v250, 0, v250
    v_max_f32 v251, 0, v251
    v_pk_mul_f32 v[248:249], v[248:249], v[248:249]
    v_pk_mul_f32 v[250:251], v[250:251], v[250:251]
    v_cvt_pk_bf16_f32 v14, v248, v249
    v_cvt_pk_bf16_f32 v15, v250, v251
    ds_write_b64 v23, v[14:15] offset:12288
    v_max_f32 v156, 0, v156
    v_max_f32 v157, 0, v157
    v_max_f32 v158, 0, v158
    v_max_f32 v159, 0, v159
    v_pk_mul_f32 v[156:157], v[156:157], v[156:157]
    v_pk_mul_f32 v[158:159], v[158:159], v[158:159]
    v_cvt_pk_bf16_f32 v8, v156, v157
    v_cvt_pk_bf16_f32 v9, v158, v159
    ds_write_b64 v20, v[8:9] offset:14336
    v_max_f32 v188, 0, v188
    v_max_f32 v189, 0, v189
    v_max_f32 v190, 0, v190
    v_max_f32 v191, 0, v191
    v_pk_mul_f32 v[188:189], v[188:189], v[188:189]
    v_pk_mul_f32 v[190:191], v[190:191], v[190:191]
    v_cvt_pk_bf16_f32 v10, v188, v189
    v_cvt_pk_bf16_f32 v11, v190, v191
    ds_write_b64 v21, v[10:11] offset:14336
    v_max_f32 v220, 0, v220
    v_max_f32 v221, 0, v221
    v_max_f32 v222, 0, v222
    v_max_f32 v223, 0, v223
    v_pk_mul_f32 v[220:221], v[220:221], v[220:221]
    v_pk_mul_f32 v[222:223], v[222:223], v[222:223]
    v_cvt_pk_bf16_f32 v12, v220, v221
    v_cvt_pk_bf16_f32 v13, v222, v223
    ds_write_b64 v22, v[12:13] offset:14336
    v_max_f32 v252, 0, v252
    v_max_f32 v253, 0, v253
    v_max_f32 v254, 0, v254
    v_max_f32 v255, 0, v255
    v_pk_mul_f32 v[252:253], v[252:253], v[252:253]
    v_pk_mul_f32 v[254:255], v[254:255], v[254:255]
    v_cvt_pk_bf16_f32 v14, v252, v253
    v_cvt_pk_bf16_f32 v15, v254, v255
    ds_write_b64 v23, v[14:15] offset:14336
    s_waitcnt lgkmcnt(0)
    s_barrier
    s_branch f_cp
p1_end:
    s_endpgm
p1_hook:
    s_cmp_gt_u32 s69, 527
    s_cbranch_scc1 p1_c_mid
    s_waitcnt vmcnt(0)
    s_branch p1_c_mid
aw_entry:
    s_load_dwordx4 s[24:27], s[0:1], 8
    s_load_dwordx4 s[28:31], s[0:1], 24
    s_load_dwordx2 s[4:5], s[0:1], 104
    s_load_dwordx2 s[36:37], s[0:1], 96
    s_and_b32 s60, s2, 7
    s_sub_u32 s61, s2, 224
    s_lshr_b32 s61, s61, 3
    s_lshr_b32 s62, s60, 2
    s_bfe_u32 s63, s60, 0x10001
    s_and_b32 s64, s60, 1
    s_lshr_b32 s65, s60, 1
    s_cmp_eq_u32 s65, 0
    s_cselect_b32 s65, 1, 0
    s_cmp_ge_u32 s45, 4
    s_cbranch_scc0 aw_compute
    s_sub_u32 s45, s45, 4
    v_lshrrev_b32 v40, 3, v1
    v_lshrrev_b32 v41, 4, v1
    v_and_b32 v42, 7, v1
    s_mul_i32 s46, s45, 262144
    v_mul_u32_u24 v43, 8192, v40
    v_xor_b32 v42, v42, v41
    v_add_u32 v43, s46, v43
    v_lshl_add_u32 v43, v42, 4, v43
    v_xor_b32 v44, 64, v43
    v_add_u32 v2, 0, v43
    v_add_u32 v3, 64512, v44
    v_add_u32 v4, 129024, v43
    v_add_u32 v5, 193536, v44
    v_lshlrev_b32 v6, 4, v1
    s_cmp_eq_u32 s45, 0
    s_cselect_b32 s46, 0, 0x7fff0000
    v_add_u32 v7, s46, v6
    s_lshl_b32 s67, s61, 1
    s_mul_i32 s46, s45, 131072
    v_mul_u32_u24 v43, 4096, v40
    v_add_u32 v43, s46, v43
    v_lshl_add_u32 v43, v42, 4, v43
    v_xor_b32 v44, 64, v43
    v_add_u32 v96, 0, v43
    v_add_u32 v97, 31744, v44
    v_add_u32 v98, 63488, v43
    v_add_u32 v99, 95232, v44
    v_lshrrev_b32 v43, 1, v1
    v_lshlrev_b32 v43, 12, v43
    v_add_u32 v43, s46, v43
    v_and_b32 v44, 1, v1
    v_lshl_add_u32 v100, v44, 4, v43
    s_mul_i32 s50, s45, 4096
    s_mul_i32 s51, s45, 9216
    s_add_u32 s51, s51, 16384
    s_mul_i32 s55, s45, 4096
    s_mov_b32 s43, 0
    s_lshl_b32 s56, s61, 8
    s_add_u32 s56, s56, s63
    s_lshl_b32 s40, s56, 12
    s_mul_i32 s41, s60, 331776
    s_mul_i32 s56, s45, 9216
    s_add_u32 s41, s41, s56
    s_lshl_b32 s54, s64, 11
    v_bfe_u32 v40, v1, 2, 2
    v_mul_u32_u24 v40, 576, v40
    v_and_b32 v41, 3, v1
    v_lshl_add_u32 v40, v41, 3, v40
    v_add_u32 v40, 16384, v40
    v_lshrrev_b32 v41, 4, v1
    s_mul_i32 s56, s45, 9216
    s_lshl_b32 s57, s61, 7
    s_add_u32 s56, s56, s57
    v_lshl_add_u32 v20, v41, 5, v40
    v_add_u32 v20, s56, v20
    v_and_b32 v41, 1, v41
    v_lshl_add_u32 v23, v41, 5, v40
    v_add_u32 v23, 512, v23
    v_lshrrev_b32 v41, 5, v1
    s_lshl_b32 s56, s45, 2
    v_add_u32 v41, s56, v41
    v_mul_u32_u24 v41, 2304, v41
    v_add_u32 v23, v23, v41
    v_mov_b32 v22, 0xbf803f80
    v_mov_b32 v24, 0
    v_mov_b32 v16, 0
    v_mov_b32 v17, 0
    v_mov_b32 v18, 0
    v_mov_b32 v25, 0
    v_mov_b32 v12, 0
    v_mov_b32 v28, 0
    v_mov_b32 v14, 0
    v_mov_b32 v29, 0
    v_mov_b32 v15, 0
    v_mov_b32 v70, 0
    v_mov_b32 v71, 0
    v_mov_b32 v72, 0
    v_mov_b32 v73, 0
    v_mov_b32 v74, 0
    v_mov_b32 v75, 0
    s_lshl_b32 s56, s45, 5
    v_and_b32 v26, 31, v1
    v_add_u32 v26, s56, v26
    v_bfe_u32 v27, v26, 1, 3
    v_lshlrev_b32 v26, 7, v26
    v_lshrrev_b32 v13, 5, v1
    v_mov_b32 v30, 153600
    s_waitcnt lgkmcnt(0)
    s_cmp_eq_u32 s62, 1
    s_cselect_b32 s24, s26, s24
    s_cselect_b32 s25, s27, s25
    s_cselect_b32 s28, s30, s28
    s_cselect_b32 s29, s31, s29
    s_mov_b32 s8, s24
    s_and_b32 s9, s25, 0xffff
    s_mov_b32 s10, 8388608
    s_mov_b32 s11, 0x00020000
    s_mov_b32 s16, s28
    s_and_b32 s17, s29, 0xffff
    s_mov_b32 s18, 2097152
    s_mov_b32 s19, 0x00020000
    s_mov_b32 s6, s4
    s_mov_b32 s7, s5
    s_add_u32 s6, s6, 25165824
    s_addc_u32 s7, s7, 0
    s_mov_b32 s12, s6
    s_and_b32 s13, s7, 0xffff
    s_mov_b32 s14, 2654208
    s_mov_b32 s15, 0x00020000
    s_cmp_eq_u32 s45, 0
    s_cbranch_scc0 ni_2
    buffer_inv sc1
    s_waitcnt vmcnt(0)
ni_2:
    s_mov_b32 s58, 0
    s_mov_b32 s59, 0
    s_lshl_b32 s59, s59, 7
    s_add_u32 s59, s59, s40
    s_add_u32 m0, s58, s50
    s_nop 0
    buffer_load_dwordx4 v2, s[8:11], s59 offen offset:0 lds
    buffer_load_dwordx4 v3, s[8:11], s59 offen offset:1024 lds
    buffer_load_dwordx4 v4, s[8:11], s59 offen offset:2048 lds
    buffer_load_dwordx4 v5, s[8:11], s59 offen offset:3072 lds
    s_mov_b32 s58, 53248
    s_mov_b32 s59, 1
    s_lshl_b32 s59, s59, 7
    s_add_u32 s59, s59, s40
    s_add_u32 m0, s58, s50
    s_nop 0
    buffer_load_dwordx4 v2, s[8:11], s59 offen offset:0 lds
    buffer_load_dwordx4 v3, s[8:11], s59 offen offset:1024 lds
    buffer_load_dwordx4 v4, s[8:11], s59 offen offset:2048 lds
    buffer_load_dwordx4 v5, s[8:11], s59 offen offset:3072 lds
    s_mov_b32 s58, 106496
    s_mov_b32 s59, 2
    s_lshl_b32 s59, s59, 7
    s_add_u32 s59, s59, s40
    s_add_u32 m0, s58, s50
    s_nop 0
    buffer_load_dwordx4 v2, s[8:11], s59 offen offset:0 lds
    buffer_load_dwordx4 v3, s[8:11], s59 offen offset:1024 lds
    buffer_load_dwordx4 v4, s[8:11], s59 offen offset:2048 lds
    buffer_load_dwordx4 v5, s[8:11], s59 offen offset:3072 lds
    v_lshlrev_b32 v8, 4, v1
    v_add_u32 v8, s55, v8
    v_add_u32 v9, 65536, v8
    s_lshl_b32 s56, s45, 10
    s_add_u32 s56, s56, 131072
    v_lshlrev_b32 v10, 4, v1
    v_add_u32 v10, s56, v10
    s_add_u32 s56, s54, 0
    buffer_load_dwordx4 v[112:115], v96, s[16:19], s56 offen offset:0
    buffer_load_dwordx4 v[116:119], v97, s[16:19], s56 offen offset:1024
    buffer_load_dwordx4 v[120:123], v98, s[16:19], s56 offen offset:2048
    buffer_load_dwordx4 v[124:127], v99, s[16:19], s56 offen offset:3072
    s_add_u32 s56, s54, 128
    buffer_load_dwordx4 v[128:131], v96, s[16:19], s56 offen offset:0
    buffer_load_dwordx4 v[132:135], v97, s[16:19], s56 offen offset:1024
    buffer_load_dwordx4 v[136:139], v98, s[16:19], s56 offen offset:2048
    buffer_load_dwordx4 v[140:143], v99, s[16:19], s56 offen offset:3072
    s_add_u32 s56, s54, 256
    buffer_load_dwordx4 v[144:147], v96, s[16:19], s56 offen offset:0
    buffer_load_dwordx4 v[148:151], v97, s[16:19], s56 offen offset:1024
    buffer_load_dwordx4 v[152:155], v98, s[16:19], s56 offen offset:2048
    buffer_load_dwordx4 v[156:159], v99, s[16:19], s56 offen offset:3072
    s_add_u32 s56, s54, 384
    buffer_load_dwordx4 v[160:163], v96, s[16:19], s56 offen offset:0
    buffer_load_dwordx4 v[164:167], v97, s[16:19], s56 offen offset:1024
    buffer_load_dwordx4 v[168:171], v98, s[16:19], s56 offen offset:2048
    buffer_load_dwordx4 v[172:175], v99, s[16:19], s56 offen offset:3072
    s_add_u32 s56, s54, 512
    buffer_load_dwordx4 v[240:243], v100, s[16:19], s56 offen
    s_mov_b32 s88, s36
    s_and_b32 s89, s37, 0xffff
    s_mov_b32 s90, 256
    s_mov_b32 s91, 0x00020000
    s_mov_b32 s34, 0
    s_mov_b32 s35, 1
    v_mov_b32 v11, 0
    buffer_load_dword v31, v11, s[88:91], 0 offen sc1
    s_mov_b32 s6, s4
    s_mov_b32 s7, s5
    s_add_u32 s6, s6, 16777216
    s_addc_u32 s7, s7, 0
    s_mov_b32 s20, s6
    s_and_b32 s21, s7, 0xffff
    s_mov_b32 s22, 2641920
    s_mov_b32 s23, 0x00020000
    s_lshl_b32 s58, s61, 2
    s_add_u32 s58, s58, s45
    s_mov_b64 exec, 0
    s_cmp_eq_u32 s58, 0
    s_cbranch_scc1 aw_l_pad0
    s_cmp_eq_u32 s58, 1
    s_cbranch_scc1 aw_l_pad1
    s_cmp_eq_u32 s58, 2
    s_cbranch_scc1 aw_l_pad2
    s_cmp_eq_u32 s58, 3
    s_cbranch_scc1 aw_l_pad3
    s_cmp_eq_u32 s58, 4
    s_cbranch_scc1 aw_l_pad4
    s_cmp_eq_u32 s58, 5
    s_cbranch_scc1 aw_l_pad5
    s_cmp_eq_u32 s58, 6
    s_cbranch_scc1 aw_l_pad6
    s_cmp_eq_u32 s58, 7
    s_cbranch_scc1 aw_l_pad7
    s_cmp_eq_u32 s58, 8
    s_cbranch_scc1 aw_l_pad8
    s_cmp_eq_u32 s58, 9
    s_cbranch_scc1 aw_l_pad9
    s_cmp_eq_u32 s58, 10
    s_cbranch_scc1 aw_l_pad10
    s_cmp_eq_u32 s58, 11
    s_cbranch_scc1 aw_l_pad11
    s_cmp_eq_u32 s58, 12
    s_cbranch_scc1 aw_l_pad12
    s_cmp_eq_u32 s58, 13
    s_cbranch_scc1 aw_l_pad13
    s_cmp_eq_u32 s58, 14
    s_cbranch_scc1 aw_l_pad14
    s_cmp_eq_u32 s58, 15
    s_cbranch_scc1 aw_l_pad15
aw_lwret:
    s_mov_b64 exec, -1
    s_barrier
aw_l_pad0:
    s_cbranch_execz aw_l_pad16
    s_mov_b32 s59, 0
    s_mul_i32 s46, s59, 36864
    s_add_u32 s46, s46, s41
    s_add_u32 m0, s43, s51
    s_nop 0
    buffer_load_dwordx4 v6, s[12:15], s46 offen offset:0 lds
    buffer_load_dwordx4 v6, s[12:15], s46 offen offset:1024 lds
    buffer_load_dwordx4 v6, s[12:15], s46 offen offset:2048 lds
    buffer_load_dwordx4 v6, s[12:15], s46 offen offset:3072 lds
    s_add_u32 m0, m0, 4096
    s_add_u32 s46, s46, 4096
    s_nop 0
    buffer_load_dwordx4 v6, s[12:15], s46 offen offset:0 lds
    buffer_load_dwordx4 v6, s[12:15], s46 offen offset:1024 lds
    buffer_load_dwordx4 v6, s[12:15], s46 offen offset:2048 lds
    buffer_load_dwordx4 v6, s[12:15], s46 offen offset:3072 lds
    s_add_u32 m0, m0, 4096
    s_add_u32 s46, s46, 4096
    s_nop 0
    buffer_load_dwordx4 v6, s[12:15], s46 offen offset:0 lds
    s_add_u32 s43, s43, 53248
    s_cmp_ge_u32 s43, 159744
    s_cselect_b32 s43, 0, s43
    s_mov_b32 s59, 1
    s_mul_i32 s46, s59, 36864
    s_add_u32 s46, s46, s41
    s_add_u32 m0, s43, s51
    s_nop 0
    buffer_load_dwordx4 v6, s[12:15], s46 offen offset:0 lds
    buffer_load_dwordx4 v6, s[12:15], s46 offen offset:1024 lds
    buffer_load_dwordx4 v6, s[12:15], s46 offen offset:2048 lds
    buffer_load_dwordx4 v6, s[12:15], s46 offen offset:3072 lds
    s_add_u32 m0, m0, 4096
    s_add_u32 s46, s46, 4096
    s_nop 0
    buffer_load_dwordx4 v6, s[12:15], s46 offen offset:0 lds
    buffer_load_dwordx4 v6, s[12:15], s46 offen offset:1024 lds
    buffer_load_dwordx4 v6, s[12:15], s46 offen offset:2048 lds
    buffer_load_dwordx4 v6, s[12:15], s46 offen offset:3072 lds
    s_add_u32 m0, m0, 4096
    s_add_u32 s46, s46, 4096
aw_l_pad1:
    s_cbranch_execz aw_l_pad17
    s_nop 0
    buffer_load_dwordx4 v6, s[12:15], s46 offen offset:0 lds
    s_add_u32 s43, s43, 53248
    s_cmp_ge_u32 s43, 159744
    s_cselect_b32 s43, 0, s43
    s_waitcnt vmcnt(9)
    s_barrier
    s_mov_b32 s59, 0x8000
np_3:
    v_readfirstlane_b32 s34, v31
    s_sub_u32 s59, s59, 1
    s_cbranch_scc1 npx_4
    s_cmp_lg_u32 s34, 0
    s_cbranch_scc1 npx_4
    buffer_load_dword v31, v11, s[88:91], 0 offen sc1
    s_waitcnt vmcnt(0)
    s_branch np_3
npx_4:
    s_mov_b32 s57, 0
    s_mov_b32 s59, 2
    s_mul_i32 s46, s59, 36864
    s_add_u32 s46, s46, s41
    s_add_u32 m0, s43, s51
    s_nop 0
    buffer_load_dwordx4 v6, s[12:15], s46 offen offset:0 lds
    buffer_load_dwordx4 v6, s[12:15], s46 offen offset:1024 lds
    buffer_load_dwordx4 v6, s[12:15], s46 offen offset:2048 lds
    buffer_load_dwordx4 v6, s[12:15], s46 offen offset:3072 lds
    s_add_u32 m0, m0, 4096
    s_add_u32 s46, s46, 4096
    s_nop 0
    buffer_load_dwordx4 v6, s[12:15], s46 offen offset:0 lds
    buffer_load_dwordx4 v6, s[12:15], s46 offen offset:1024 lds
    buffer_load_dwordx4 v6, s[12:15], s46 offen offset:2048 lds
    buffer_load_dwordx4 v6, s[12:15], s46 offen offset:3072 lds
    s_add_u32 m0, m0, 4096
    s_add_u32 s46, s46, 4096
    s_nop 0
    buffer_load_dwordx4 v6, s[12:15], s46 offen offset:0 lds
    s_add_u32 s43, s43, 53248
    s_cmp_ge_u32 s43, 159744
    s_cselect_b32 s43, 0, s43
    s_cmp_eq_u32 s65, 1
aw_l_pad2:
    s_cbranch_execz aw_l_pad18
    s_cbranch_scc0 ns_5
    v_add_u32 v21, s57, v20
    ds_read_b64_tr_b16 v[36:37], v21 offset:0
    ds_read_b64_tr_b16 v[38:39], v21 offset:2304
    ds_read_b64_tr_b16 v[40:41], v21 offset:4608
    ds_read_b64_tr_b16 v[42:43], v21 offset:6912
    s_cmp_eq_u32 s61, 0
    s_cbranch_scc0 sz_7
    v_add_u32 v19, s57, v23
    ds_read_b64_tr_b16 v[32:33], v19 offset:0
    ds_read_b64_tr_b16 v[34:35], v19 offset:4608
    s_waitcnt lgkmcnt(0)
    v_dot2_f32_bf16 v25, v32, v22, v25
    v_dot2_f32_bf16 v12, v33, v22, v12
    v_dot2_f32_bf16 v25, v34, v22, v25
    v_dot2_f32_bf16 v12, v35, v22, v12
sz_7:
    s_waitcnt lgkmcnt(0)
    v_dot2_f32_bf16 v24, v36, v22, v24
    v_dot2_f32_bf16 v16, v37, v22, v16
    v_dot2_f32_bf16 v17, v38, v22, v17
    v_dot2_f32_bf16 v18, v39, v22, v18
    v_dot2_f32_bf16 v24, v40, v22, v24
    v_dot2_f32_bf16 v16, v41, v22, v16
    v_dot2_f32_bf16 v17, v42, v22, v17
    v_dot2_f32_bf16 v18, v43, v22, v18
sae_6:
ns_5:
    s_add_u32 s57, s57, 53248
    s_cmp_ge_u32 s57, 159744
    s_cselect_b32 s57, 0, s57
    s_waitcnt vmcnt(9)
    s_barrier
    s_mov_b32 s59, 3
    s_lshl_b32 s59, s59, 7
    s_add_u32 s59, s59, s40
    s_add_u32 m0, s43, s50
    s_nop 0
    buffer_load_dwordx4 v2, s[8:11], s59 offen offset:0 lds
    buffer_load_dwordx4 v3, s[8:11], s59 offen offset:1024 lds
    buffer_load_dwordx4 v4, s[8:11], s59 offen offset:2048 lds
    buffer_load_dwordx4 v5, s[8:11], s59 offen offset:3072 lds
    s_mov_b32 s59, 3
    s_mul_i32 s46, s59, 36864
aw_l_pad3:
    s_cbranch_execz aw_l_pad19
    s_add_u32 s46, s46, s41
    s_add_u32 m0, s43, s51
    s_nop 0
    buffer_load_dwordx4 v6, s[12:15], s46 offen offset:0 lds
    buffer_load_dwordx4 v6, s[12:15], s46 offen offset:1024 lds
    buffer_load_dwordx4 v6, s[12:15], s46 offen offset:2048 lds
    buffer_load_dwordx4 v6, s[12:15], s46 offen offset:3072 lds
    s_add_u32 m0, m0, 4096
    s_add_u32 s46, s46, 4096
    s_nop 0
    buffer_load_dwordx4 v6, s[12:15], s46 offen offset:0 lds
    buffer_load_dwordx4 v6, s[12:15], s46 offen offset:1024 lds
    buffer_load_dwordx4 v6, s[12:15], s46 offen offset:2048 lds
    buffer_load_dwordx4 v6, s[12:15], s46 offen offset:3072 lds
    s_add_u32 m0, m0, 4096
    s_add_u32 s46, s46, 4096
    s_nop 0
    buffer_load_dwordx4 v6, s[12:15], s46 offen offset:0 lds
    s_add_u32 s43, s43, 53248
    s_cmp_ge_u32 s43, 159744
    s_cselect_b32 s43, 0, s43
    s_add_u32 s56, s54, 524288
    buffer_load_dwordx4 v[176:179], v96, s[16:19], s56 offen offset:0
    s_add_u32 s56, s54, 524288
    buffer_load_dwordx4 v[180:183], v97, s[16:19], s56 offen offset:1024
    s_add_u32 s56, s54, 524288
    buffer_load_dwordx4 v[184:187], v98, s[16:19], s56 offen offset:2048
    s_cmp_eq_u32 s65, 1
    s_cbranch_scc0 ns_8
    v_add_u32 v21, s57, v20
    ds_read_b64_tr_b16 v[36:37], v21 offset:0
    ds_read_b64_tr_b16 v[38:39], v21 offset:2304
    ds_read_b64_tr_b16 v[40:41], v21 offset:4608
    ds_read_b64_tr_b16 v[42:43], v21 offset:6912
    s_cmp_eq_u32 s61, 0
    s_cbranch_scc0 sz_10
    v_add_u32 v19, s57, v23
    ds_read_b64_tr_b16 v[32:33], v19 offset:0
    ds_read_b64_tr_b16 v[34:35], v19 offset:4608
    s_waitcnt lgkmcnt(0)
    v_dot2_f32_bf16 v25, v32, v22, v25
aw_l_pad4:
    s_cbranch_execz aw_l_pad20
    v_dot2_f32_bf16 v12, v33, v22, v12
    v_dot2_f32_bf16 v25, v34, v22, v25
    v_dot2_f32_bf16 v12, v35, v22, v12
sz_10:
    s_waitcnt lgkmcnt(0)
    v_dot2_f32_bf16 v24, v36, v22, v24
    v_dot2_f32_bf16 v16, v37, v22, v16
    v_dot2_f32_bf16 v17, v38, v22, v17
    v_dot2_f32_bf16 v18, v39, v22, v18
    v_dot2_f32_bf16 v24, v40, v22, v24
    v_dot2_f32_bf16 v16, v41, v22, v16
    v_dot2_f32_bf16 v17, v42, v22, v17
    v_dot2_f32_bf16 v18, v43, v22, v18
sae_9:
ns_8:
    s_add_u32 s57, s57, 53248
    s_cmp_ge_u32 s57, 159744
    s_cselect_b32 s57, 0, s57
    s_waitcnt vmcnt(16)
    s_barrier
    s_mov_b32 s59, 4
    s_lshl_b32 s59, s59, 7
    s_add_u32 s59, s59, s40
    s_add_u32 m0, s43, s50
    s_nop 0
    buffer_load_dwordx4 v2, s[8:11], s59 offen offset:0 lds
    buffer_load_dwordx4 v3, s[8:11], s59 offen offset:1024 lds
    buffer_load_dwordx4 v4, s[8:11], s59 offen offset:2048 lds
    buffer_load_dwordx4 v5, s[8:11], s59 offen offset:3072 lds
    s_mov_b32 s59, 4
    s_mul_i32 s46, s59, 36864
    s_add_u32 s46, s46, s41
    s_add_u32 m0, s43, s51
    s_nop 0
    buffer_load_dwordx4 v6, s[12:15], s46 offen offset:0 lds
    buffer_load_dwordx4 v6, s[12:15], s46 offen offset:1024 lds
    buffer_load_dwordx4 v6, s[12:15], s46 offen offset:2048 lds
    buffer_load_dwordx4 v6, s[12:15], s46 offen offset:3072 lds
    s_add_u32 m0, m0, 4096
    s_add_u32 s46, s46, 4096
    s_nop 0
    buffer_load_dwordx4 v6, s[12:15], s46 offen offset:0 lds
    buffer_load_dwordx4 v6, s[12:15], s46 offen offset:1024 lds
    buffer_load_dwordx4 v6, s[12:15], s46 offen offset:2048 lds
aw_l_pad5:
    s_cbranch_execz aw_l_pad21
    buffer_load_dwordx4 v6, s[12:15], s46 offen offset:3072 lds
    s_add_u32 m0, m0, 4096
    s_add_u32 s46, s46, 4096
    s_nop 0
    buffer_load_dwordx4 v6, s[12:15], s46 offen offset:0 lds
    s_add_u32 s43, s43, 53248
    s_cmp_ge_u32 s43, 159744
    s_cselect_b32 s43, 0, s43
    s_add_u32 s56, s54, 524288
    buffer_load_dwordx4 v[188:191], v99, s[16:19], s56 offen offset:3072
    s_add_u32 s56, s54, 524416
    buffer_load_dwordx4 v[192:195], v96, s[16:19], s56 offen offset:0
    s_add_u32 s56, s54, 524416
    buffer_load_dwordx4 v[196:199], v97, s[16:19], s56 offen offset:1024
    s_cmp_eq_u32 s65, 1
    s_cbranch_scc0 ns_11
    v_add_u32 v21, s57, v20
    ds_read_b64_tr_b16 v[36:37], v21 offset:0
    ds_read_b64_tr_b16 v[38:39], v21 offset:2304
    ds_read_b64_tr_b16 v[40:41], v21 offset:4608
    ds_read_b64_tr_b16 v[42:43], v21 offset:6912
    s_cmp_eq_u32 s61, 0
    s_cbranch_scc0 sz_13
    v_add_u32 v19, s57, v23
    ds_read_b64_tr_b16 v[32:33], v19 offset:0
    ds_read_b64_tr_b16 v[34:35], v19 offset:4608
    s_waitcnt lgkmcnt(0)
    v_dot2_f32_bf16 v25, v32, v22, v25
    v_dot2_f32_bf16 v12, v33, v22, v12
    v_dot2_f32_bf16 v25, v34, v22, v25
    v_dot2_f32_bf16 v12, v35, v22, v12
sz_13:
    s_waitcnt lgkmcnt(0)
    v_dot2_f32_bf16 v24, v36, v22, v24
    v_dot2_f32_bf16 v16, v37, v22, v16
    v_dot2_f32_bf16 v17, v38, v22, v17
    v_dot2_f32_bf16 v18, v39, v22, v18
    v_dot2_f32_bf16 v24, v40, v22, v24
    v_dot2_f32_bf16 v16, v41, v22, v16
    v_dot2_f32_bf16 v17, v42, v22, v17
    v_dot2_f32_bf16 v18, v43, v22, v18
sae_12:
ns_11:
    s_add_u32 s57, s57, 53248
aw_l_pad6:
    s_cbranch_execz aw_l_pad22
    s_cmp_ge_u32 s57, 159744
    s_cselect_b32 s57, 0, s57
    s_waitcnt vmcnt(19)
    s_barrier
    s_mov_b32 s59, 5
    s_lshl_b32 s59, s59, 7
    s_add_u32 s59, s59, s40
    s_add_u32 m0, s43, s50
    s_nop 0
    buffer_load_dwordx4 v2, s[8:11], s59 offen offset:0 lds
    buffer_load_dwordx4 v3, s[8:11], s59 offen offset:1024 lds
    buffer_load_dwordx4 v4, s[8:11], s59 offen offset:2048 lds
    buffer_load_dwordx4 v5, s[8:11], s59 offen offset:3072 lds
    s_mov_b32 s59, 5
    s_mul_i32 s46, s59, 36864
    s_add_u32 s46, s46, s41
    s_add_u32 m0, s43, s51
    s_nop 0
    buffer_load_dwordx4 v6, s[12:15], s46 offen offset:0 lds
    buffer_load_dwordx4 v6, s[12:15], s46 offen offset:1024 lds
    buffer_load_dwordx4 v6, s[12:15], s46 offen offset:2048 lds
    buffer_load_dwordx4 v6, s[12:15], s46 offen offset:3072 lds
    s_add_u32 m0, m0, 4096
    s_add_u32 s46, s46, 4096
    s_nop 0
    buffer_load_dwordx4 v6, s[12:15], s46 offen offset:0 lds
    buffer_load_dwordx4 v6, s[12:15], s46 offen offset:1024 lds
    buffer_load_dwordx4 v6, s[12:15], s46 offen offset:2048 lds
    buffer_load_dwordx4 v6, s[12:15], s46 offen offset:3072 lds
    s_add_u32 m0, m0, 4096
    s_add_u32 s46, s46, 4096
    s_nop 0
    buffer_load_dwordx4 v6, s[12:15], s46 offen offset:0 lds
    s_add_u32 s43, s43, 53248
    s_cmp_ge_u32 s43, 159744
    s_cselect_b32 s43, 0, s43
    s_add_u32 s56, s54, 524416
    buffer_load_dwordx4 v[200:203], v98, s[16:19], s56 offen offset:2048
    s_add_u32 s56, s54, 524416
    buffer_load_dwordx4 v[204:207], v99, s[16:19], s56 offen offset:3072
    s_add_u32 s56, s54, 524544
aw_l_pad7:
    s_cbranch_execz aw_l_pad23
    buffer_load_dwordx4 v[208:211], v96, s[16:19], s56 offen offset:0
    s_cmp_eq_u32 s65, 1
    s_cbranch_scc0 ns_14
    v_add_u32 v21, s57, v20
    ds_read_b64_tr_b16 v[36:37], v21 offset:0
    ds_read_b64_tr_b16 v[38:39], v21 offset:2304
    ds_read_b64_tr_b16 v[40:41], v21 offset:4608
    ds_read_b64_tr_b16 v[42:43], v21 offset:6912
    s_cmp_eq_u32 s61, 0
    s_cbranch_scc0 sz_16
    v_add_u32 v19, s57, v23
    ds_read_b64_tr_b16 v[32:33], v19 offset:0
    ds_read_b64_tr_b16 v[34:35], v19 offset:4608
    s_waitcnt lgkmcnt(0)
    v_dot2_f32_bf16 v25, v32, v22, v25
    v_dot2_f32_bf16 v12, v33, v22, v12
    v_dot2_f32_bf16 v25, v34, v22, v25
    v_dot2_f32_bf16 v12, v35, v22, v12
sz_16:
    s_waitcnt lgkmcnt(0)
    v_dot2_f32_bf16 v24, v36, v22, v24
    v_dot2_f32_bf16 v16, v37, v22, v16
    v_dot2_f32_bf16 v17, v38, v22, v17
    v_dot2_f32_bf16 v18, v39, v22, v18
    v_dot2_f32_bf16 v24, v40, v22, v24
    v_dot2_f32_bf16 v16, v41, v22, v16
    v_dot2_f32_bf16 v17, v42, v22, v17
    v_dot2_f32_bf16 v18, v43, v22, v18
sae_15:
ns_14:
    s_add_u32 s57, s57, 53248
    s_cmp_ge_u32 s57, 159744
    s_cselect_b32 s57, 0, s57
    s_waitcnt vmcnt(19)
    s_barrier
    s_mov_b32 s59, 6
    s_lshl_b32 s59, s59, 7
    s_add_u32 s59, s59, s40
    s_add_u32 m0, s43, s50
    s_nop 0
    buffer_load_dwordx4 v2, s[8:11], s59 offen offset:0 lds
    buffer_load_dwordx4 v3, s[8:11], s59 offen offset:1024 lds
    buffer_load_dwordx4 v4, s[8:11], s59 offen offset:2048 lds
    buffer_load_dwordx4 v5, s[8:11], s59 offen offset:3072 lds
aw_l_pad8:
    s_cbranch_execz aw_lwret
    s_mov_b32 s59, 6
    s_mul_i32 s46, s59, 36864
    s_add_u32 s46, s46, s41
    s_add_u32 m0, s43, s51
    s_nop 0
    buffer_load_dwordx4 v6, s[12:15], s46 offen offset:0 lds
    buffer_load_dwordx4 v6, s[12:15], s46 offen offset:1024 lds
    buffer_load_dwordx4 v6, s[12:15], s46 offen offset:2048 lds
    buffer_load_dwordx4 v6, s[12:15], s46 offen offset:3072 lds
    s_add_u32 m0, m0, 4096
    s_add_u32 s46, s46, 4096
    s_nop 0
    buffer_load_dwordx4 v6, s[12:15], s46 offen offset:0 lds
    buffer_load_dwordx4 v6, s[12:15], s46 offen offset:1024 lds
    buffer_load_dwordx4 v6, s[12:15], s46 offen offset:2048 lds
    buffer_load_dwordx4 v6, s[12:15], s46 offen offset:3072 lds
    s_add_u32 m0, m0, 4096
    s_add_u32 s46, s46, 4096
    s_nop 0
    buffer_load_dwordx4 v6, s[12:15], s46 offen offset:0 lds
    s_add_u32 s43, s43, 53248
    s_cmp_ge_u32 s43, 159744
    s_cselect_b32 s43, 0, s43
    s_add_u32 s56, s54, 524544
    buffer_load_dwordx4 v[212:215], v97, s[16:19], s56 offen offset:1024
    s_add_u32 s56, s54, 524544
    buffer_load_dwordx4 v[216:219], v98, s[16:19], s56 offen offset:2048
    s_add_u32 s56, s54, 524544
    buffer_load_dwordx4 v[220:223], v99, s[16:19], s56 offen offset:3072
    s_cmp_eq_u32 s65, 1
    s_cbranch_scc0 ns_17
    v_add_u32 v21, s57, v20
    ds_read_b64_tr_b16 v[36:37], v21 offset:0
    ds_read_b64_tr_b16 v[38:39], v21 offset:2304
    ds_read_b64_tr_b16 v[40:41], v21 offset:4608
    ds_read_b64_tr_b16 v[42:43], v21 offset:6912
    s_cmp_eq_u32 s61, 0
    s_cbranch_scc0 sz_19
    v_add_u32 v19, s57, v23
    ds_read_b64_tr_b16 v[32:33], v19 offset:0
    ds_read_b64_tr_b16 v[34:35], v19 offset:4608
aw_l_pad9:
    s_cbranch_execz aw_lwret
    s_waitcnt lgkmcnt(0)
    v_dot2_f32_bf16 v25, v32, v22, v25
    v_dot2_f32_bf16 v12, v33, v22, v12
    v_dot2_f32_bf16 v25, v34, v22, v25
    v_dot2_f32_bf16 v12, v35, v22, v12
sz_19:
    s_waitcnt lgkmcnt(0)
    v_dot2_f32_bf16 v24, v36, v22, v24
    v_dot2_f32_bf16 v16, v37, v22, v16
    v_dot2_f32_bf16 v17, v38, v22, v17
    v_dot2_f32_bf16 v18, v39, v22, v18
    v_dot2_f32_bf16 v24, v40, v22, v24
    v_dot2_f32_bf16 v16, v41, v22, v16
    v_dot2_f32_bf16 v17, v42, v22, v17
    v_dot2_f32_bf16 v18, v43, v22, v18
sae_18:
ns_17:
    s_add_u32 s57, s57, 53248
    s_cmp_ge_u32 s57, 159744
    s_cselect_b32 s57, 0, s57
    s_waitcnt vmcnt(19)
    s_barrier
    s_mov_b32 s59, 7
    s_lshl_b32 s59, s59, 7
    s_add_u32 s59, s59, s40
    s_add_u32 m0, s43, s50
    s_nop 0
    buffer_load_dwordx4 v2, s[8:11], s59 offen offset:0 lds
    buffer_load_dwordx4 v3, s[8:11], s59 offen offset:1024 lds
    buffer_load_dwordx4 v4, s[8:11], s59 offen offset:2048 lds
    buffer_load_dwordx4 v5, s[8:11], s59 offen offset:3072 lds
    s_mov_b32 s59, 7
    s_mul_i32 s46, s59, 36864
    s_add_u32 s46, s46, s41
    s_add_u32 m0, s43, s51
    s_nop 0
    buffer_load_dwordx4 v6, s[12:15], s46 offen offset:0 lds
    buffer_load_dwordx4 v6, s[12:15], s46 offen offset:1024 lds
    buffer_load_dwordx4 v6, s[12:15], s46 offen offset:2048 lds
    buffer_load_dwordx4 v6, s[12:15], s46 offen offset:3072 lds
    s_add_u32 m0, m0, 4096
    s_add_u32 s46, s46, 4096
    s_nop 0
    buffer_load_dwordx4 v6, s[12:15], s46 offen offset:0 lds
aw_l_pad10:
    s_cbranch_execz aw_lwret
    buffer_load_dwordx4 v6, s[12:15], s46 offen offset:1024 lds
    buffer_load_dwordx4 v6, s[12:15], s46 offen offset:2048 lds
    buffer_load_dwordx4 v6, s[12:15], s46 offen offset:3072 lds
    s_add_u32 m0, m0, 4096
    s_add_u32 s46, s46, 4096
    s_nop 0
    buffer_load_dwordx4 v6, s[12:15], s46 offen offset:0 lds
    s_add_u32 s43, s43, 53248
    s_cmp_ge_u32 s43, 159744
    s_cselect_b32 s43, 0, s43
    s_add_u32 s56, s54, 524672
    buffer_load_dwordx4 v[224:227], v96, s[16:19], s56 offen offset:0
    s_add_u32 s56, s54, 524672
    buffer_load_dwordx4 v[228:231], v97, s[16:19], s56 offen offset:1024
    s_add_u32 s56, s54, 524672
    buffer_load_dwordx4 v[232:235], v98, s[16:19], s56 offen offset:2048
    s_cmp_eq_u32 s65, 1
    s_cbranch_scc0 ns_20
    v_add_u32 v21, s57, v20
    ds_read_b64_tr_b16 v[36:37], v21 offset:0
    ds_read_b64_tr_b16 v[38:39], v21 offset:2304
    ds_read_b64_tr_b16 v[40:41], v21 offset:4608
    ds_read_b64_tr_b16 v[42:43], v21 offset:6912
    s_cmp_eq_u32 s61, 0
    s_cbranch_scc0 sz_22
    v_add_u32 v19, s57, v23
    ds_read_b64_tr_b16 v[32:33], v19 offset:0
    ds_read_b64_tr_b16 v[34:35], v19 offset:4608
    s_waitcnt lgkmcnt(0)
    v_dot2_f32_bf16 v25, v32, v22, v25
    v_dot2_f32_bf16 v12, v33, v22, v12
    v_dot2_f32_bf16 v25, v34, v22, v25
    v_dot2_f32_bf16 v12, v35, v22, v12
sz_22:
    s_waitcnt lgkmcnt(0)
    v_dot2_f32_bf16 v24, v36, v22, v24
    v_dot2_f32_bf16 v16, v37, v22, v16
    v_dot2_f32_bf16 v17, v38, v22, v17
    v_dot2_f32_bf16 v18, v39, v22, v18
    v_dot2_f32_bf16 v24, v40, v22, v24
    v_dot2_f32_bf16 v16, v41, v22, v16
    v_dot2_f32_bf16 v17, v42, v22, v17
aw_l_pad11:
    s_cbranch_execz aw_lwret
    v_dot2_f32_bf16 v18, v43, v22, v18
sae_21:
ns_20:
    s_add_u32 s57, s57, 53248
    s_cmp_ge_u32 s57, 159744
    s_cselect_b32 s57, 0, s57
    s_waitcnt vmcnt(19)
    s_barrier
    s_mov_b32 s59, 8
    s_lshl_b32 s59, s59, 7
    s_add_u32 s59, s59, s40
    s_add_u32 m0, s43, s50
    s_nop 0
    buffer_load_dwordx4 v2, s[8:11], s59 offen offset:0 lds
    buffer_load_dwordx4 v3, s[8:11], s59 offen offset:1024 lds
    buffer_load_dwordx4 v4, s[8:11], s59 offen offset:2048 lds
    buffer_load_dwordx4 v5, s[8:11], s59 offen offset:3072 lds
    s_mov_b32 s59, 8
    s_mul_i32 s46, s59, 36864
    s_add_u32 s46, s46, s41
    s_add_u32 m0, s43, s51
    s_nop 0
    buffer_load_dwordx4 v7, s[12:15], s46 offen offset:0 lds
    buffer_load_dwordx4 v7, s[12:15], s46 offen offset:1024 lds
    buffer_load_dwordx4 v7, s[12:15], s46 offen offset:2048 lds
    buffer_load_dwordx4 v7, s[12:15], s46 offen offset:3072 lds
    s_add_u32 m0, m0, 4096
    s_add_u32 s46, s46, 4096
    s_nop 0
    buffer_load_dwordx4 v7, s[12:15], s46 offen offset:0 lds
    buffer_load_dwordx4 v7, s[12:15], s46 offen offset:1024 lds
    buffer_load_dwordx4 v7, s[12:15], s46 offen offset:2048 lds
    buffer_load_dwordx4 v7, s[12:15], s46 offen offset:3072 lds
    s_add_u32 m0, m0, 4096
    s_add_u32 s46, s46, 4096
    s_nop 0
    buffer_load_dwordx4 v7, s[12:15], s46 offen offset:0 lds
    s_add_u32 s43, s43, 53248
    s_cmp_ge_u32 s43, 159744
    s_cselect_b32 s43, 0, s43
    s_add_u32 s56, s54, 524672
    buffer_load_dwordx4 v[236:239], v99, s[16:19], s56 offen offset:3072
    s_add_u32 s56, s54, 524800
aw_l_pad12:
    s_cbranch_execz aw_lwret
    buffer_load_dwordx4 v[244:247], v100, s[16:19], s56 offen
    s_cmp_eq_u32 s65, 1
    s_cbranch_scc0 ns_23
    v_add_u32 v21, s57, v20
    ds_read_b64_tr_b16 v[36:37], v21 offset:0
    ds_read_b64_tr_b16 v[38:39], v21 offset:2304
    ds_read_b64_tr_b16 v[40:41], v21 offset:4608
    ds_read_b64_tr_b16 v[42:43], v21 offset:6912
    s_cmp_eq_u32 s61, 0
    s_cbranch_scc0 sz_25
    v_add_u32 v19, s57, v23
    ds_read_b64_tr_b16 v[32:33], v19 offset:0
    ds_read_b64_tr_b16 v[34:35], v19 offset:4608
    s_waitcnt lgkmcnt(0)
    v_dot2_f32_bf16 v25, v32, v22, v25
    v_dot2_f32_bf16 v12, v33, v22, v12
    v_dot2_f32_bf16 v25, v34, v22, v25
    v_dot2_f32_bf16 v12, v35, v22, v12
sz_25:
    s_waitcnt lgkmcnt(0)
    v_dot2_f32_bf16 v24, v36, v22, v24
    v_dot2_f32_bf16 v16, v37, v22, v16
    v_dot2_f32_bf16 v17, v38, v22, v17
    v_dot2_f32_bf16 v18, v39, v22, v18
    v_dot2_f32_bf16 v24, v40, v22, v24
    v_dot2_f32_bf16 v16, v41, v22, v16
    v_dot2_f32_bf16 v17, v42, v22, v17
    v_dot2_f32_bf16 v18, v43, v22, v18
sae_24:
ns_23:
    s_add_u32 s57, s57, 53248
    s_cmp_ge_u32 s57, 159744
    s_cselect_b32 s57, 0, s57
    s_waitcnt vmcnt(18)
    s_barrier
    s_cmp_eq_u32 s65, 1
    s_cbranch_scc0 ns_26
    v_add_u32 v21, s57, v20
    ds_read_b64_tr_b16 v[36:37], v21 offset:0
    ds_read_b64_tr_b16 v[38:39], v21 offset:2304
    ds_read_b64_tr_b16 v[40:41], v21 offset:4608
    ds_read_b64_tr_b16 v[42:43], v21 offset:6912
    s_cmp_eq_u32 s61, 0
    s_cbranch_scc0 sz_28
aw_l_pad13:
    s_cbranch_execz aw_lwret
    v_add_u32 v19, s57, v23
    ds_read_b64_tr_b16 v[32:33], v19 offset:0
    ds_read_b64_tr_b16 v[34:35], v19 offset:4608
    s_waitcnt lgkmcnt(0)
    v_dot2_f32_bf16 v25, v32, v22, v25
    v_dot2_f32_bf16 v12, v33, v22, v12
    v_dot2_f32_bf16 v25, v34, v22, v25
    v_dot2_f32_bf16 v12, v35, v22, v12
sz_28:
    s_waitcnt lgkmcnt(0)
    v_dot2_f32_bf16 v24, v36, v22, v24
    v_dot2_f32_bf16 v16, v37, v22, v16
    v_dot2_f32_bf16 v17, v38, v22, v17
    v_dot2_f32_bf16 v18, v39, v22, v18
    v_dot2_f32_bf16 v24, v40, v22, v24
    v_dot2_f32_bf16 v16, v41, v22, v16
    v_dot2_f32_bf16 v17, v42, v22, v17
    v_dot2_f32_bf16 v18, v43, v22, v18
sae_27:
ns_26:
    s_add_u32 s57, s57, 53248
    s_cmp_ge_u32 s57, 159744
    s_cselect_b32 s57, 0, s57
    s_waitcnt vmcnt(0)
    s_barrier
    s_cmp_eq_u32 s65, 1
    s_cbranch_scc0 ns_29
    s_cmp_eq_u32 s45, 0
    s_cbranch_scc0 sae_30
    v_add_u32 v21, s57, v20
    ds_read_b64_tr_b16 v[36:37], v21 offset:0
    ds_read_b64_tr_b16 v[38:39], v21 offset:2304
    ds_read_b64_tr_b16 v[40:41], v21 offset:4608
    ds_read_b64_tr_b16 v[42:43], v21 offset:6912
    s_cmp_eq_u32 s61, 0
    s_cbranch_scc0 sz_31
    v_add_u32 v19, s57, v23
    ds_read_b64_tr_b16 v[32:33], v19 offset:0
    ds_read_b64_tr_b16 v[34:35], v19 offset:4608
    s_waitcnt lgkmcnt(0)
    v_dot2_f32_bf16 v25, v32, v22, v25
    v_dot2_f32_bf16 v12, v33, v22, v12
    v_dot2_f32_bf16 v25, v34, v22, v25
    v_dot2_f32_bf16 v12, v35, v22, v12
sz_31:
aw_l_pad14:
    s_cbranch_execz aw_lwret
    s_waitcnt lgkmcnt(0)
    v_dot2_f32_bf16 v24, v36, v22, v24
    v_dot2_f32_bf16 v16, v37, v22, v16
    v_dot2_f32_bf16 v17, v38, v22, v17
    v_dot2_f32_bf16 v18, v39, v22, v18
    v_dot2_f32_bf16 v24, v40, v22, v24
    v_dot2_f32_bf16 v16, v41, v22, v16
    v_dot2_f32_bf16 v17, v42, v22, v17
    v_dot2_f32_bf16 v18, v43, v22, v18
sae_30:
    v_add_f32 v24, v24, v16
    v_add_f32 v17, v17, v18
    v_add_f32 v24, v24, v17
    v_add_f32 v25, v25, v12
    s_lshl_b32 s56, s45, 8
    v_lshlrev_b32 v41, 2, v1
    v_add_u32 v41, s56, v41
    v_add_u32 v41, 154624, v41
    ds_write_b32 v41, v25
    ds_write_b32 v41, v24 offset:1024
ns_29:
    ds_write_b128 v8, v[112:115] offset:0
    ds_write_b128 v8, v[116:119] offset:1024
    ds_write_b128 v8, v[120:123] offset:2048
    ds_write_b128 v8, v[124:127] offset:3072
    ds_write_b128 v8, v[128:131] offset:16384
    ds_write_b128 v8, v[132:135] offset:17408
    ds_write_b128 v8, v[136:139] offset:18432
    ds_write_b128 v8, v[140:143] offset:19456
    s_barrier
    ds_write_b128 v8, v[144:147] offset:32768
    ds_write_b128 v8, v[148:151] offset:33792
    ds_write_b128 v8, v[152:155] offset:34816
    ds_write_b128 v8, v[156:159] offset:35840
    ds_write_b128 v8, v[160:163] offset:49152
    ds_write_b128 v8, v[164:167] offset:50176
    ds_write_b128 v8, v[168:171] offset:51200
    ds_write_b128 v8, v[172:175] offset:52224
    ds_write_b128 v10, v[240:243] offset:0
    s_waitcnt lgkmcnt(0)
    s_barrier
    ds_write_b128 v9, v[176:179] offset:0
    ds_write_b128 v9, v[180:183] offset:1024
aw_l_pad15:
    s_cbranch_execz aw_lwret
    ds_write_b128 v9, v[184:187] offset:2048
    ds_write_b128 v9, v[188:191] offset:3072
    ds_write_b128 v9, v[192:195] offset:16384
    ds_write_b128 v9, v[196:199] offset:17408
    ds_write_b128 v9, v[200:203] offset:18432
    ds_write_b128 v9, v[204:207] offset:19456
    ds_write_b128 v9, v[208:211] offset:32768
    ds_write_b128 v9, v[212:215] offset:33792
    ds_write_b128 v9, v[216:219] offset:34816
    ds_write_b128 v9, v[220:223] offset:35840
    ds_write_b128 v9, v[224:227] offset:49152
    ds_write_b128 v9, v[228:231] offset:50176
    ds_write_b128 v9, v[232:235] offset:51200
    ds_write_b128 v9, v[236:239] offset:52224
    ds_write_b128 v10, v[244:247] offset:4096
    s_waitcnt lgkmcnt(0)
    s_cmp_eq_u32 s65, 1
    s_cbranch_scc0 ns_32
    v_and_b32 v40, 31, v1
    v_lshlrev_b32 v41, 2, v40
    v_add_u32 v41, 154624, v41
    ds_read_b32 v32, v41 offset:0
    ds_read_b32 v33, v41 offset:128
    ds_read_b32 v34, v41 offset:256
    ds_read_b32 v35, v41 offset:384
    ds_read_b32 v36, v41 offset:512
    ds_read_b32 v37, v41 offset:640
    ds_read_b32 v38, v41 offset:768
    ds_read_b32 v39, v41 offset:896
    v_lshlrev_b32 v42, 2, v1
    v_add_u32 v42, 155648, v42
    ds_read_b32 v52, v42 offset:0
    ds_read_b32 v53, v42 offset:256
    ds_read_b32 v54, v42 offset:512
    ds_read_b32 v55, v42 offset:768
    s_waitcnt lgkmcnt(0)
    v_add_f32 v32, v32, v33
    v_add_f32 v32, v32, v34
    v_add_f32 v32, v32, v35
    v_add_f32 v32, v32, v36
    v_add_f32 v32, v32, v37
aw_l_pad16:
    s_cbranch_execz aw_lwret
    v_add_f32 v32, v32, v38
    v_add_f32 v32, v32, v39
    v_add_f32 v52, v52, v53
    v_add_f32 v52, v52, v54
    v_add_f32 v52, v52, v55
    v_cvt_pk_bf16_f32 v32, v32, v32
    v_lshlrev_b32 v41, 1, v40
    v_add_u32 v41, 154112, v41
    v_cvt_pk_bf16_f32 v52, v52, v52
    v_lshlrev_b32 v42, 1, v1
    v_add_u32 v42, 153600, v42
    ds_write_b16 v41, v32
    ds_write_b16 v42, v52
    s_waitcnt lgkmcnt(0)
    s_mul_i32 s56, s61, 16384
    v_lshl_add_u32 v31, v13, 2, 0
    v_xor_b32 v11, v31, v27
    v_lshl_add_u32 v32, v11, 4, v26
    v_add_u32 v32, s56, v32
    v_add_u32 v36, 65536, v32
    v_lshl_add_u32 v40, v31, 4, v30
    v_lshl_add_u32 v31, v13, 2, 1
    v_xor_b32 v11, v31, v27
    v_lshl_add_u32 v33, v11, 4, v26
    v_add_u32 v33, s56, v33
    v_add_u32 v37, 65536, v33
    v_lshl_add_u32 v41, v31, 4, v30
    v_lshl_add_u32 v31, v13, 2, 2
    v_xor_b32 v11, v31, v27
    v_lshl_add_u32 v34, v11, 4, v26
    v_add_u32 v34, s56, v34
    v_add_u32 v38, 65536, v34
    v_lshl_add_u32 v42, v31, 4, v30
    v_lshl_add_u32 v31, v13, 2, 3
    v_xor_b32 v11, v31, v27
    v_lshl_add_u32 v35, v11, 4, v26
    v_add_u32 v35, s56, v35
    v_add_u32 v39, 65536, v35
    v_lshl_add_u32 v43, v31, 4, v30
    v_lshrrev_b32 v44, 2, v26
    v_lshl_add_u32 v44, v13, 4, v44
aw_l_pad17:
    s_cbranch_execz aw_lwret
    v_add_u32 v44, 131072, v44
    v_lshl_add_u32 v45, v13, 4, v30
    ds_read_b128 v[176:179], v40
    ds_read_b128 v[180:183], v41
    ds_read_b128 v[184:187], v42
    ds_read_b128 v[188:191], v43
    ds_read_b128 v[192:195], v45 offset:512
    s_waitcnt lgkmcnt(0)
    ds_read_b128 v[112:115], v32
    ds_read_b128 v[116:119], v33
    ds_read_b128 v[120:123], v34
    ds_read_b128 v[124:127], v35
    ds_read_b128 v[48:51], v44 offset:0
    s_waitcnt lgkmcnt(4)
    v_dot2_f32_bf16 v28, v112, v176, v28
    v_dot2_f32_bf16 v14, v113, v177, v14
    v_dot2_f32_bf16 v28, v114, v178, v28
    v_dot2_f32_bf16 v14, v115, v179, v14
    s_waitcnt lgkmcnt(3)
    v_dot2_f32_bf16 v28, v116, v180, v28
    v_dot2_f32_bf16 v14, v117, v181, v14
    v_dot2_f32_bf16 v28, v118, v182, v28
    v_dot2_f32_bf16 v14, v119, v183, v14
    s_waitcnt lgkmcnt(2)
    v_dot2_f32_bf16 v28, v120, v184, v28
    v_dot2_f32_bf16 v14, v121, v185, v14
    v_dot2_f32_bf16 v28, v122, v186, v28
    v_dot2_f32_bf16 v14, v123, v187, v14
    s_waitcnt lgkmcnt(1)
    v_dot2_f32_bf16 v28, v124, v188, v28
    v_dot2_f32_bf16 v14, v125, v189, v14
    v_dot2_f32_bf16 v28, v126, v190, v28
    v_dot2_f32_bf16 v14, v127, v191, v14
    s_waitcnt lgkmcnt(0)
    s_cmp_eq_u32 s61, 0
    s_cbranch_scc0 sb_33
    v_dot2_f32_bf16 v28, v48, v192, v28
    v_dot2_f32_bf16 v14, v49, v193, v14
    v_dot2_f32_bf16 v28, v50, v194, v28
    v_dot2_f32_bf16 v14, v51, v195, v14
sb_33:
ns_32:
    s_barrier
aw_l_pad18:
    s_cbranch_execz aw_lwret
    s_cmp_eq_u32 s65, 1
    s_cbranch_scc0 ns_34
    ds_read_b128 v[112:115], v36
    ds_read_b128 v[116:119], v37
    ds_read_b128 v[120:123], v38
    ds_read_b128 v[124:127], v39
    ds_read_b128 v[48:51], v44 offset:4096
    s_waitcnt lgkmcnt(4)
    v_dot2_f32_bf16 v29, v112, v176, v29
    v_dot2_f32_bf16 v15, v113, v177, v15
    v_dot2_f32_bf16 v29, v114, v178, v29
    v_dot2_f32_bf16 v15, v115, v179, v15
    s_waitcnt lgkmcnt(3)
    v_dot2_f32_bf16 v29, v116, v180, v29
    v_dot2_f32_bf16 v15, v117, v181, v15
    v_dot2_f32_bf16 v29, v118, v182, v29
    v_dot2_f32_bf16 v15, v119, v183, v15
    s_waitcnt lgkmcnt(2)
    v_dot2_f32_bf16 v29, v120, v184, v29
    v_dot2_f32_bf16 v15, v121, v185, v15
    v_dot2_f32_bf16 v29, v122, v186, v29
    v_dot2_f32_bf16 v15, v123, v187, v15
    s_waitcnt lgkmcnt(1)
    v_dot2_f32_bf16 v29, v124, v188, v29
    v_dot2_f32_bf16 v15, v125, v189, v15
    v_dot2_f32_bf16 v29, v126, v190, v29
    v_dot2_f32_bf16 v15, v127, v191, v15
    s_waitcnt lgkmcnt(0)
    s_cmp_eq_u32 s61, 0
    s_cbranch_scc0 sb_35
    v_dot2_f32_bf16 v29, v48, v192, v29
    v_dot2_f32_bf16 v15, v49, v193, v15
    v_dot2_f32_bf16 v29, v50, v194, v29
    v_dot2_f32_bf16 v15, v51, v195, v15
sb_35:
ns_34:
    s_barrier
    s_cmp_eq_u32 s65, 1
    s_cbranch_scc0 ns_36
    v_add_f32 v28, v28, v14
    v_add_f32 v29, v29, v15
    v_mov_b32 v32, v28
    v_mov_b32 v33, v29
aw_l_pad19:
    s_cbranch_execz aw_lwret
    s_nop 1
    v_permlane32_swap_b32 v32, v28
    v_permlane32_swap_b32 v33, v29
    s_nop 1
    v_add_f32 v28, v28, v32
    v_add_f32 v29, v29, v33
    s_mov_b32 s6, s4
    s_mov_b32 s7, s5
    s_add_u32 s6, s6, 16777216
    s_addc_u32 s7, s7, 0
    s_mov_b32 s20, s6
    s_and_b32 s21, s7, 0xffff
    s_mov_b32 s22, 2641920
    s_mov_b32 s23, 0x00020000
    s_mul_i32 s56, s64, 660480
    s_add_u32 s56, s56, 655360
    s_mul_i32 s57, s61, 640
    s_add_u32 s56, s56, s57
    v_cvt_pk_bf16_f32 v31, v28, v28
    v_cvt_pk_bf16_f32 v12, v29, v29
    s_lshl_b32 s57, s45, 6
    v_and_b32 v40, 31, v1
    v_lshlrev_b32 v40, 1, v40
    v_add_u32 v40, s57, v40
    v_cmp_gt_u32 vcc, 32, v1
    v_mov_b32 v42, 0x7ffffff0
    s_nop 0
    v_cndmask_b32 v40, v42, v40, vcc
    buffer_store_short v31, v40, s[20:23], s56 offen sc0 sc1
    buffer_store_short v12, v40, s[20:23], s56 offen offset:256 sc0 sc1
    v_mov_b32 v32, 0
    v_mov_b32 v41, 154144
    ds_read_u16 v33, v41
    v_mov_b32 v43, 512
    v_cmp_eq_u32 vcc, 0, v1
    s_nop 1
    v_cndmask_b32 v43, v42, v43, vcc
    s_waitcnt lgkmcnt(0)
    s_cmp_eq_u32 s61, 0
    s_cbranch_scc1 ns_37
    v_mov_b32 v33, 0
ns_37:
aw_l_pad20:
    s_cbranch_execz aw_lwret
    s_cmp_eq_u32 s45, 0
    s_cbranch_scc0 ns_38
    buffer_store_short v33, v43, s[20:23], s56 offen sc0 sc1
ns_38:
    s_cmp_eq_u32 s61, 0
    s_cbranch_scc0 ns_39
    s_add_u32 s57, s56, 1320960
    buffer_store_short v32, v40, s[20:23], s57 offen sc0 sc1
    buffer_store_short v32, v40, s[20:23], s57 offen offset:256 sc0 sc1
    s_cmp_eq_u32 s45, 0
    s_cbranch_scc0 ns_40
    buffer_store_short v32, v43, s[20:23], s57 offen sc0 sc1
ns_40:
ns_39:
ns_36:
    s_mov_b32 s6, s4
    s_mov_b32 s7, s5
    s_add_u32 s6, s6, 16777216
    s_addc_u32 s7, s7, 0
    s_mov_b32 s20, s6
    s_and_b32 s21, s7, 0xffff
    s_mov_b32 s22, 2641920
    s_mov_b32 s23, 0x00020000
    s_lshl_b32 s56, s62, 1
    s_add_u32 s56, s56, s64
    s_mul_i32 s56, s56, 660480
    s_lshl_b32 s57, s45, 14
    v_lshrrev_b32 v44, 5, v1
    v_and_b32 v45, 31, v1
    s_lshl_b32 s58, s61, 8
    s_add_u32 s58, s58, s63
    s_lshl_b32 s59, s45, 6
    s_add_u32 s58, s58, s59
    v_lshl_add_u32 v46, v44, 1, s58
    v_mul_u32_u24 v46, 640, v46
    v_lshl_add_u32 v46, v45, 4, v46
    v_add_u32 v47, 0, v44
    v_xor_b32 v56, v45, v47
    v_lshlrev_b32 v47, 9, v47
    v_lshl_add_u32 v47, v56, 4, v47
    v_add_u32 v104, s57, v47
    v_add_u32 v47, 2, v44
    v_xor_b32 v56, v45, v47
    v_lshlrev_b32 v47, 9, v47
    v_lshl_add_u32 v47, v56, 4, v47
aw_l_pad21:
    s_cbranch_execz aw_lwret
    v_add_u32 v105, s57, v47
    v_add_u32 v47, 4, v44
    v_xor_b32 v56, v45, v47
    v_lshlrev_b32 v47, 9, v47
    v_lshl_add_u32 v47, v56, 4, v47
    v_add_u32 v106, s57, v47
    v_add_u32 v47, 6, v44
    v_xor_b32 v56, v45, v47
    v_lshlrev_b32 v47, 9, v47
    v_lshl_add_u32 v47, v56, 4, v47
    v_add_u32 v107, s57, v47
    v_lshrrev_b32 v44, 4, v1
    v_and_b32 v45, 15, v1
    v_lshl_add_u32 v48, v44, 1, s58
    v_mul_u32_u24 v48, 640, v48
    v_lshl_add_u32 v48, v45, 4, v48
    v_and_b32 v47, 7, v45
    v_and_b32 v51, 8, v45
    v_add_u32 v52, 0, v44
    v_xor_b32 v53, v47, v52
    v_or_b32 v53, v51, v53
    v_lshlrev_b32 v52, 9, v52
    v_lshl_add_u32 v52, v53, 4, v52
    v_add_u32 v49, s57, v52
    v_add_u32 v52, 4, v44
    v_xor_b32 v53, v47, v52
    v_or_b32 v53, v51, v53
    v_lshlrev_b32 v52, 9, v52
    v_lshl_add_u32 v52, v53, 4, v52
    v_add_u32 v50, s57, v52
    ds_read_b128 v[64:67], v49 offset:0
    ds_read_b128 v[68:71], v50 offset:0
    ds_read_b128 v[72:75], v49 offset:4096
    ds_read_b128 v[76:79], v50 offset:4096
    ds_read_b128 v[80:83], v49 offset:8192
    ds_read_b128 v[84:87], v50 offset:8192
    ds_read_b128 v[88:91], v49 offset:12288
    ds_read_b128 v[92:95], v50 offset:12288
    s_waitcnt lgkmcnt(7)
    s_add_u32 s59, s56, 0
    buffer_store_dwordx4 v[64:67], v48, s[20:23], s59 offen sc0 sc1
aw_l_pad22:
    s_cbranch_execz aw_lwret
    s_waitcnt lgkmcnt(6)
    s_add_u32 s59, s56, 5120
    buffer_store_dwordx4 v[68:71], v48, s[20:23], s59 offen sc0 sc1
    s_waitcnt lgkmcnt(5)
    s_add_u32 s59, s56, 10240
    buffer_store_dwordx4 v[72:75], v48, s[20:23], s59 offen sc0 sc1
    s_waitcnt lgkmcnt(4)
    s_add_u32 s59, s56, 15360
    buffer_store_dwordx4 v[76:79], v48, s[20:23], s59 offen sc0 sc1
    s_waitcnt lgkmcnt(3)
    s_add_u32 s59, s56, 20480
    buffer_store_dwordx4 v[80:83], v48, s[20:23], s59 offen sc0 sc1
    s_waitcnt lgkmcnt(2)
    s_add_u32 s59, s56, 25600
    buffer_store_dwordx4 v[84:87], v48, s[20:23], s59 offen sc0 sc1
    s_waitcnt lgkmcnt(1)
    s_add_u32 s59, s56, 30720
    buffer_store_dwordx4 v[88:91], v48, s[20:23], s59 offen sc0 sc1
    s_waitcnt lgkmcnt(0)
    s_add_u32 s59, s56, 35840
    buffer_store_dwordx4 v[92:95], v48, s[20:23], s59 offen sc0 sc1
    s_barrier
    ds_read_b128 v[64:67], v49 offset:256
    ds_read_b128 v[68:71], v50 offset:256
    ds_read_b128 v[72:75], v49 offset:4352
    ds_read_b128 v[76:79], v50 offset:4352
    ds_read_b128 v[80:83], v49 offset:8448
    ds_read_b128 v[84:87], v50 offset:8448
    ds_read_b128 v[88:91], v49 offset:12544
    ds_read_b128 v[92:95], v50 offset:12544
    s_waitcnt lgkmcnt(7)
    s_add_u32 s59, s56, 256
    buffer_store_dwordx4 v[64:67], v48, s[20:23], s59 offen sc0 sc1
    s_waitcnt lgkmcnt(6)
    s_add_u32 s59, s56, 5376
    buffer_store_dwordx4 v[68:71], v48, s[20:23], s59 offen sc0 sc1
    s_waitcnt lgkmcnt(5)
    s_add_u32 s59, s56, 10496
    buffer_store_dwordx4 v[72:75], v48, s[20:23], s59 offen sc0 sc1
    s_waitcnt lgkmcnt(4)
    s_add_u32 s59, s56, 15616
aw_l_pad23:
    s_cbranch_execz aw_lwret
    buffer_store_dwordx4 v[76:79], v48, s[20:23], s59 offen sc0 sc1
    s_waitcnt lgkmcnt(3)
    s_add_u32 s59, s56, 20736
    buffer_store_dwordx4 v[80:83], v48, s[20:23], s59 offen sc0 sc1
    s_waitcnt lgkmcnt(2)
    s_add_u32 s59, s56, 25856
    buffer_store_dwordx4 v[84:87], v48, s[20:23], s59 offen sc0 sc1
    s_waitcnt lgkmcnt(1)
    s_add_u32 s59, s56, 30976
    buffer_store_dwordx4 v[88:91], v48, s[20:23], s59 offen sc0 sc1
    s_waitcnt lgkmcnt(0)
    s_add_u32 s59, s56, 36096
    buffer_store_dwordx4 v[92:95], v48, s[20:23], s59 offen sc0 sc1
    s_sub_u32 s58, s2, 224
    s_lshl_b32 s58, s58, 2
    s_add_u32 s58, s58, 65536
    v_lshlrev_b32 v28, 7, v1
    v_add_u32 v28, s58, v28
    v_mov_b32 v25, 0x7ffffff0
    v_cmp_gt_u32 vcc, 8, v1
    s_nop 1
    v_cndmask_b32 v28, v25, v28, vcc
    s_branch f_ld
aw_compute:
    v_bfe_u32 v40, v1, 2, 2
    v_lshrrev_b32 v41, 5, v1
    v_lshl_add_u32 v41, v41, 3, v40
    v_mul_u32_u24 v41, 576, v41
    v_add_u32 v41, 16384, v41
    v_bfe_u32 v42, v1, 4, 1
    v_lshl_add_u32 v41, v42, 5, v41
    v_and_b32 v42, 3, v1
    v_lshl_add_u32 v2, v42, 3, v41
    v_and_b32 v40, 31, v1
    s_lshl_b32 s48, s45, 12
    v_lshlrev_b32 v43, 7, v40
    v_add_u32 v43, s48, v43
    v_lshrrev_b32 v41, 5, v1
    v_bfe_u32 v42, v1, 1, 3
    v_xor_b32 v41, v41, v42
    v_xor_b32 v44, 0, v41
    v_lshl_add_u32 v3, v44, 4, v43
    v_xor_b32 v44, 2, v41
    v_lshl_add_u32 v4, v44, 4, v43
    v_xor_b32 v44, 4, v41
    v_lshl_add_u32 v5, v44, 4, v43
    v_xor_b32 v44, 6, v41
    v_lshl_add_u32 v6, v44, 4, v43
    v_lshlrev_b32 v43, 7, v40
    v_xor_b32 v44, 0, v41
    v_lshl_add_u32 v8, v44, 4, v43
    v_xor_b32 v44, 2, v41
    v_lshl_add_u32 v9, v44, 4, v43
    v_xor_b32 v44, 4, v41
    v_lshl_add_u32 v10, v44, 4, v43
    v_xor_b32 v44, 6, v41
    v_lshl_add_u32 v11, v44, 4, v43
    v_lshlrev_b32 v43, 5, v40
    v_lshrrev_b32 v44, 5, v1
    v_lshl_add_u32 v7, v44, 4, v43
    v_add_u32 v7, 131072, v7
    v_mov_b32 v112, 0
    v_mov_b32 v113, 0
    v_mov_b32 v114, 0
    v_mov_b32 v115, 0
    v_mov_b32 v116, 0
    v_mov_b32 v117, 0
    v_mov_b32 v118, 0
    v_mov_b32 v119, 0
    v_mov_b32 v120, 0
    v_mov_b32 v121, 0
    v_mov_b32 v122, 0
    v_mov_b32 v123, 0
    v_mov_b32 v124, 0
    v_mov_b32 v125, 0
    v_mov_b32 v126, 0
    v_mov_b32 v127, 0
    v_mov_b32 v128, 0
    v_mov_b32 v129, 0
    v_mov_b32 v130, 0
    v_mov_b32 v131, 0
    v_mov_b32 v132, 0
    v_mov_b32 v133, 0
    v_mov_b32 v134, 0
    v_mov_b32 v135, 0
    v_mov_b32 v136, 0
    v_mov_b32 v137, 0
    v_mov_b32 v138, 0
    v_mov_b32 v139, 0
    v_mov_b32 v140, 0
    v_mov_b32 v141, 0
    v_mov_b32 v142, 0
    v_mov_b32 v143, 0
    v_mov_b32 v144, 0
    v_mov_b32 v145, 0
    v_mov_b32 v146, 0
    v_mov_b32 v147, 0
    v_mov_b32 v148, 0
    v_mov_b32 v149, 0
    v_mov_b32 v150, 0
    v_mov_b32 v151, 0
    v_mov_b32 v152, 0
    v_mov_b32 v153, 0
    v_mov_b32 v154, 0
    v_mov_b32 v155, 0
    v_mov_b32 v156, 0
    v_mov_b32 v157, 0
    v_mov_b32 v158, 0
    v_mov_b32 v159, 0
    v_mov_b32 v160, 0
    v_mov_b32 v161, 0
    v_mov_b32 v162, 0
    v_mov_b32 v163, 0
    v_mov_b32 v164, 0
    v_mov_b32 v165, 0
    v_mov_b32 v166, 0
    v_mov_b32 v167, 0
    v_mov_b32 v168, 0
    v_mov_b32 v169, 0
    v_mov_b32 v170, 0
    v_mov_b32 v171, 0
    v_mov_b32 v172, 0
    v_mov_b32 v173, 0
    v_mov_b32 v174, 0
    v_mov_b32 v175, 0
    v_mov_b32 v176, 0
    v_mov_b32 v177, 0
    v_mov_b32 v178, 0
    v_mov_b32 v179, 0
    v_mov_b32 v180, 0
    v_mov_b32 v181, 0
    v_mov_b32 v182, 0
    v_mov_b32 v183, 0
    v_mov_b32 v184, 0
    v_mov_b32 v185, 0
    v_mov_b32 v186, 0
    v_mov_b32 v187, 0
    v_mov_b32 v188, 0
    v_mov_b32 v189, 0
    v_mov_b32 v190, 0
    v_mov_b32 v191, 0
    v_mov_b32 v192, 0
    v_mov_b32 v193, 0
    v_mov_b32 v194, 0
    v_mov_b32 v195, 0
    v_mov_b32 v196, 0
    v_mov_b32 v197, 0
    v_mov_b32 v198, 0
    v_mov_b32 v199, 0
    v_mov_b32 v200, 0
    v_mov_b32 v201, 0
    v_mov_b32 v202, 0
    v_mov_b32 v203, 0
    v_mov_b32 v204, 0
    v_mov_b32 v205, 0
    v_mov_b32 v206, 0
    v_mov_b32 v207, 0
    v_mov_b32 v208, 0
    v_mov_b32 v209, 0
    v_mov_b32 v210, 0
    v_mov_b32 v211, 0
    v_mov_b32 v212, 0
    v_mov_b32 v213, 0
    v_mov_b32 v214, 0
    v_mov_b32 v215, 0
    v_mov_b32 v216, 0
    v_mov_b32 v217, 0
    v_mov_b32 v218, 0
    v_mov_b32 v219, 0
    v_mov_b32 v220, 0
    v_mov_b32 v221, 0
    v_mov_b32 v222, 0
    v_mov_b32 v223, 0
    v_mov_b32 v224, 0
    v_mov_b32 v225, 0
    v_mov_b32 v226, 0
    v_mov_b32 v227, 0
    v_mov_b32 v228, 0
    v_mov_b32 v229, 0
    v_mov_b32 v230, 0
    v_mov_b32 v231, 0
    v_mov_b32 v232, 0
    v_mov_b32 v233, 0
    v_mov_b32 v234, 0
    v_mov_b32 v235, 0
    v_mov_b32 v236, 0
    v_mov_b32 v237, 0
    v_mov_b32 v238, 0
    v_mov_b32 v239, 0
    v_mov_b32 v240, 0
    v_mov_b32 v241, 0
    v_mov_b32 v242, 0
    v_mov_b32 v243, 0
    v_mov_b32 v244, 0
    v_mov_b32 v245, 0
    v_mov_b32 v246, 0
    v_mov_b32 v247, 0
    v_mov_b32 v248, 0
    v_mov_b32 v249, 0
    v_mov_b32 v250, 0
    v_mov_b32 v251, 0
    v_mov_b32 v252, 0
    v_mov_b32 v253, 0
    v_mov_b32 v254, 0
    v_mov_b32 v255, 0
    s_mov_b32 s52, 4294860800
    s_mov_b32 s53, 53248
    s_lshl_b32 s56, s61, 8
    s_add_u32 s56, s56, s63
    s_lshl_b32 s40, s56, 12
    s_lshl_b32 s54, s64, 11
    s_mov_b32 s68, 0
    s_waitcnt lgkmcnt(0)
    s_cmp_eq_u32 s62, 1
    s_cselect_b32 s24, s26, s24
    s_cselect_b32 s25, s27, s25
    s_cselect_b32 s28, s30, s28
    s_cselect_b32 s29, s31, s29
    s_mov_b32 s8, s24
    s_and_b32 s9, s25, 0xffff
    s_mov_b32 s10, 8388608
    s_mov_b32 s11, 0x00020000
    s_mov_b32 s16, s28
    s_and_b32 s17, s29, 0xffff
    s_mov_b32 s18, 2097152
    s_mov_b32 s19, 0x00020000
    s_mov_b32 s88, s36
    s_and_b32 s89, s37, 0xffff
    s_mov_b32 s90, 256
    s_mov_b32 s91, 0x00020000
    s_mov_b32 s6, s4
    s_mov_b32 s7, s5
    s_add_u32 s6, s6, 35651584
    s_addc_u32 s7, s7, 0
    s_mov_b32 s92, s6
    s_and_b32 s93, s7, 0xffff
    s_mov_b32 s94, 4224
    s_mov_b32 s95, 0x00020000
    v_lshlrev_b32 v101, 7, v1
    v_cmp_gt_u32 vcc, 33, v1
    v_mov_b32 v102, 0x7ffffff0
    s_nop 0
    v_cndmask_b32 v101, v102, v101, vcc
    s_mov_b32 s66, 0
    s_mov_b32 s69, 0x10000
    s_mov_b64 s[56:57], -1
    s_cmp_eq_u32 s45, 0
    s_cbranch_scc1 pp_41
    v_lshlrev_b32 v102, 13, v1
    s_lshl_b32 s58, s45, 1
    s_add_u32 s58, s58, 1
    s_lshl_b32 s58, s58, 7
    s_add_u32 s58, s58, s40
    buffer_load_dword v100, v102, s[8:11], s58 offen
    s_add_u32 s58, s58, 524288
    buffer_load_dword v100, v102, s[8:11], s58 offen
    s_lshl_b32 s58, s45, 1
    s_add_u32 s58, s58, 2
    s_lshl_b32 s58, s58, 7
    s_add_u32 s58, s58, s40
    buffer_load_dword v100, v102, s[8:11], s58 offen
    s_add_u32 s58, s58, 524288
    buffer_load_dword v100, v102, s[8:11], s58 offen
pfe_43:
    s_lshl_b32 s58, s61, 5
    s_add_u32 s58, s58, 128
    v_and_b32 v102, 31, v1
    v_add_u32 v102, s58, v102
    v_lshlrev_b32 v102, 12, v102
    v_lshrrev_b32 v104, 5, v1
    v_lshl_add_u32 v102, v104, 7, v102
    s_sub_u32 s58, s45, 1
    s_lshl_b32 s58, s58, 8
    s_add_u32 s58, s58, s54
    buffer_load_dword v100, v102, s[16:19], s58 offen
    s_mov_b32 s6, s4
    s_mov_b32 s7, s5
    s_add_u32 s6, s6, 16777216
    s_addc_u32 s7, s7, 0
    s_mov_b32 s20, s6
    s_and_b32 s21, s7, 0xffff
    s_mov_b32 s22, 2641920
    s_mov_b32 s23, 0x00020000
    s_mul_i32 s58, s61, 3
    s_add_u32 s58, s58, s45
    s_sub_u32 s58, s58, 1
    s_mov_b64 exec, 0
    s_cmp_eq_u32 s58, 0
    s_cbranch_scc1 aw_c_pad0
    s_cmp_eq_u32 s58, 1
    s_cbranch_scc1 aw_c_pad1
    s_cmp_eq_u32 s58, 2
    s_cbranch_scc1 aw_c_pad2
    s_cmp_eq_u32 s58, 3
    s_cbranch_scc1 aw_c_pad3
    s_cmp_eq_u32 s58, 4
    s_cbranch_scc1 aw_c_pad4
    s_cmp_eq_u32 s58, 5
    s_cbranch_scc1 aw_c_pad5
    s_cmp_eq_u32 s58, 6
    s_cbranch_scc1 aw_c_pad6
    s_cmp_eq_u32 s58, 7
    s_cbranch_scc1 aw_c_pad7
    s_cmp_eq_u32 s58, 8
    s_cbranch_scc1 aw_c_pad8
    s_cmp_eq_u32 s58, 9
    s_cbranch_scc1 aw_c_pad9
    s_cmp_eq_u32 s58, 10
    s_cbranch_scc1 aw_c_pad10
    s_cmp_eq_u32 s58, 11
    s_cbranch_scc1 aw_c_pad11
aw_cwret:
    s_mov_b64 exec, -1
    s_branch pf0_42
pp_41:
    v_mov_b32 v102, 0
np_44:
    buffer_load_dword v96, v102, s[88:91], 0 offen sc1
    s_waitcnt vmcnt(0)
    v_readfirstlane_b32 s66, v96
    s_sub_u32 s69, s69, 1
    s_cbranch_scc1 npx_45
    s_cmp_lg_u32 s66, 0
    s_cbranch_scc1 npx_45
    s_sleep 8
    s_branch np_44
npx_45:
    s_mov_b32 s69, 0x10000
    s_mov_b32 s68, 1
    s_mov_b32 s69, 0x8000
pc_46:
    s_and_b32 s58, s56, 0xff
    s_cbranch_scc0 pd_47
    s_sub_u32 s69, s69, 1
    s_cbranch_scc1 pd_47
    buffer_load_dwordx4 v[96:99], v101, s[92:95], 0 offen sc1
    s_waitcnt vmcnt(0)
    v_xor_b32 v96, s66, v96
    v_xor_b32 v97, s66, v97
    v_xor_b32 v98, s66, v98
    v_xor_b32 v99, s66, v99
    v_or_b32 v96, v96, v97
    v_or_b32 v98, v98, v99
    v_or_b32 v96, v96, v98
    v_cmp_ne_u32 s[56:57], 0, v96
    s_nop 4
    s_branch pc_46
pd_47:
pf0_42:
    s_barrier
    s_cmp_eq_u32 s68, 1
    s_cbranch_scc0 pq_48
    s_mov_b32 s69, 0x8000
pc_49:
    s_and_b32 s58, s56, 0xfff
    s_cbranch_scc0 pd_50
    s_sub_u32 s69, s69, 1
    s_cbranch_scc1 pd_50
    buffer_load_dwordx4 v[96:99], v101, s[92:95], 0 offen sc1
    s_waitcnt vmcnt(0)
    v_xor_b32 v96, s66, v96
    v_xor_b32 v97, s66, v97
    v_xor_b32 v98, s66, v98
    v_xor_b32 v99, s66, v99
    v_or_b32 v96, v96, v97
    v_or_b32 v98, v98, v99
    v_or_b32 v96, v96, v98
    v_cmp_ne_u32 s[56:57], 0, v96
    s_nop 4
    s_branch pc_49
pd_50:
    s_and_b32 s58, s57, 1
    s_or_b32 s58, s58, s56
    s_cselect_b32 s68, 1, 0
    buffer_load_dwordx4 v[96:99], v101, s[92:95], 0 offen sc1
pq_48:
    s_barrier
    ds_read_b128 v[52:55], v3
    ds_read_b64_tr_b16 v[16:17], v2 offset:0
    ds_read_b64_tr_b16 v[18:19], v2 offset:2304
    ds_read_b64_tr_b16 v[20:21], v2 offset:64
    ds_read_b64_tr_b16 v[22:23], v2 offset:2368
    ds_read_b64_tr_b16 v[24:25], v2 offset:128
    ds_read_b64_tr_b16 v[26:27], v2 offset:2432
    ds_read_b64_tr_b16 v[28:29], v2 offset:192
    ds_read_b64_tr_b16 v[30:31], v2 offset:2496
    ds_read_b64_tr_b16 v[32:33], v2 offset:256
    ds_read_b64_tr_b16 v[34:35], v2 offset:2560
    ds_read_b64_tr_b16 v[36:37], v2 offset:320
    ds_read_b64_tr_b16 v[38:39], v2 offset:2624
    ds_read_b64_tr_b16 v[40:41], v2 offset:384
    ds_read_b64_tr_b16 v[42:43], v2 offset:2688
    ds_read_b64_tr_b16 v[44:45], v2 offset:448
    ds_read_b64_tr_b16 v[46:47], v2 offset:2752
    ds_read_b64_tr_b16 v[48:49], v2 offset:512
    ds_read_b64_tr_b16 v[50:51], v2 offset:2816
    s_mov_b32 s44, 8
    s_mov_b32 s49, 0
.p2align 6
aw_aloop:
    s_waitcnt lgkmcnt(0)
    v_mfma_f32_32x32x16_bf16 v[112:127], v[16:19], v[52:55], v[112:127]
    ds_read_b128 v[92:95], v4
    ds_read_b64_tr_b16 v[56:57], v2 offset:9216
    ds_read_b64_tr_b16 v[58:59], v2 offset:11520
    v_mfma_f32_32x32x16_bf16 v[128:143], v[20:23], v[52:55], v[128:143]
    ds_read_b64_tr_b16 v[60:61], v2 offset:9280
    ds_read_b64_tr_b16 v[62:63], v2 offset:11584
    ds_read_b64_tr_b16 v[64:65], v2 offset:9344
    v_mfma_f32_32x32x16_bf16 v[144:159], v[24:27], v[52:55], v[144:159]
    ds_read_b64_tr_b16 v[66:67], v2 offset:11648
    ds_read_b64_tr_b16 v[68:69], v2 offset:9408
    ds_read_b64_tr_b16 v[70:71], v2 offset:11712
    v_mfma_f32_32x32x16_bf16 v[160:175], v[28:31], v[52:55], v[160:175]
    ds_read_b64_tr_b16 v[72:73], v2 offset:9472
    ds_read_b64_tr_b16 v[74:75], v2 offset:11776
    ds_read_b64_tr_b16 v[76:77], v2 offset:9536
    v_mfma_f32_32x32x16_bf16 v[176:191], v[32:35], v[52:55], v[176:191]
    ds_read_b64_tr_b16 v[78:79], v2 offset:11840
    ds_read_b64_tr_b16 v[80:81], v2 offset:9600
    ds_read_b64_tr_b16 v[82:83], v2 offset:11904
    v_mfma_f32_32x32x16_bf16 v[192:207], v[36:39], v[52:55], v[192:207]
    ds_read_b64_tr_b16 v[84:85], v2 offset:9664
    ds_read_b64_tr_b16 v[86:87], v2 offset:11968
    ds_read_b64_tr_b16 v[88:89], v2 offset:9728
    v_mfma_f32_32x32x16_bf16 v[208:223], v[40:43], v[52:55], v[208:223]
    ds_read_b64_tr_b16 v[90:91], v2 offset:12032
    v_mfma_f32_32x32x16_bf16 v[224:239], v[44:47], v[52:55], v[224:239]
    v_mfma_f32_32x32x16_bf16 v[240:255], v[48:51], v[52:55], v[240:255]
    s_waitcnt lgkmcnt(0)
    v_mfma_f32_32x32x16_bf16 v[112:127], v[56:59], v[92:95], v[112:127]
    ds_read_b128 v[52:55], v5
    ds_read_b64_tr_b16 v[16:17], v2 offset:18432
    ds_read_b64_tr_b16 v[18:19], v2 offset:20736
    v_mfma_f32_32x32x16_bf16 v[128:143], v[60:63], v[92:95], v[128:143]
    ds_read_b64_tr_b16 v[20:21], v2 offset:18496
    ds_read_b64_tr_b16 v[22:23], v2 offset:20800
    ds_read_b64_tr_b16 v[24:25], v2 offset:18560
    v_mfma_f32_32x32x16_bf16 v[144:159], v[64:67], v[92:95], v[144:159]
    ds_read_b64_tr_b16 v[26:27], v2 offset:20864
    ds_read_b64_tr_b16 v[28:29], v2 offset:18624
    ds_read_b64_tr_b16 v[30:31], v2 offset:20928
    v_mfma_f32_32x32x16_bf16 v[160:175], v[68:71], v[92:95], v[160:175]
    ds_read_b64_tr_b16 v[32:33], v2 offset:18688
    ds_read_b64_tr_b16 v[34:35], v2 offset:20992
    ds_read_b64_tr_b16 v[36:37], v2 offset:18752
    v_mfma_f32_32x32x16_bf16 v[176:191], v[72:75], v[92:95], v[176:191]
    ds_read_b64_tr_b16 v[38:39], v2 offset:21056
    ds_read_b64_tr_b16 v[40:41], v2 offset:18816
    ds_read_b64_tr_b16 v[42:43], v2 offset:21120
    v_mfma_f32_32x32x16_bf16 v[192:207], v[76:79], v[92:95], v[192:207]
    ds_read_b64_tr_b16 v[44:45], v2 offset:18880
    ds_read_b64_tr_b16 v[46:47], v2 offset:21184
    ds_read_b64_tr_b16 v[48:49], v2 offset:18944
    v_mfma_f32_32x32x16_bf16 v[208:223], v[80:83], v[92:95], v[208:223]
    ds_read_b64_tr_b16 v[50:51], v2 offset:21248
    v_mfma_f32_32x32x16_bf16 v[224:239], v[84:87], v[92:95], v[224:239]
    v_mfma_f32_32x32x16_bf16 v[240:255], v[88:91], v[92:95], v[240:255]
    s_waitcnt lgkmcnt(0)
    v_mfma_f32_32x32x16_bf16 v[112:127], v[16:19], v[52:55], v[112:127]
    ds_read_b128 v[92:95], v6
    ds_read_b64_tr_b16 v[56:57], v2 offset:27648
    ds_read_b64_tr_b16 v[58:59], v2 offset:29952
    v_mfma_f32_32x32x16_bf16 v[128:143], v[20:23], v[52:55], v[128:143]
    ds_read_b64_tr_b16 v[60:61], v2 offset:27712
    ds_read_b64_tr_b16 v[62:63], v2 offset:30016
    ds_read_b64_tr_b16 v[64:65], v2 offset:27776
    v_mfma_f32_32x32x16_bf16 v[144:159], v[24:27], v[52:55], v[144:159]
    ds_read_b64_tr_b16 v[66:67], v2 offset:30080
    ds_read_b64_tr_b16 v[68:69], v2 offset:27840
    ds_read_b64_tr_b16 v[70:71], v2 offset:30144
    v_mfma_f32_32x32x16_bf16 v[160:175], v[28:31], v[52:55], v[160:175]
    ds_read_b64_tr_b16 v[72:73], v2 offset:27904
    ds_read_b64_tr_b16 v[74:75], v2 offset:30208
    ds_read_b64_tr_b16 v[76:77], v2 offset:27968
    v_mfma_f32_32x32x16_bf16 v[176:191], v[32:35], v[52:55], v[176:191]
    ds_read_b64_tr_b16 v[78:79], v2 offset:30272
    ds_read_b64_tr_b16 v[80:81], v2 offset:28032
    ds_read_b64_tr_b16 v[82:83], v2 offset:30336
    v_mfma_f32_32x32x16_bf16 v[192:207], v[36:39], v[52:55], v[192:207]
    ds_read_b64_tr_b16 v[84:85], v2 offset:28096
    ds_read_b64_tr_b16 v[86:87], v2 offset:30400
    ds_read_b64_tr_b16 v[88:89], v2 offset:28160
    v_mfma_f32_32x32x16_bf16 v[208:223], v[40:43], v[52:55], v[208:223]
    ds_read_b64_tr_b16 v[90:91], v2 offset:30464
    v_mfma_f32_32x32x16_bf16 v[224:239], v[44:47], v[52:55], v[224:239]
    v_mfma_f32_32x32x16_bf16 v[240:255], v[48:51], v[52:55], v[240:255]
    s_cmp_eq_u32 s68, 1
    s_cbranch_scc1 aw_chk
aw_chkret:
    s_waitcnt lgkmcnt(0)
    s_barrier
    v_mfma_f32_32x32x16_bf16 v[112:127], v[56:59], v[92:95], v[112:127]
    s_add_u32 s49, s49, 53248
    s_cmp_ge_u32 s49, 159744
    s_cselect_b32 s48, s52, s53
    s_cselect_b32 s49, 0, s49
    v_add_u32 v2, s48, v2
    v_add_u32 v3, s48, v3
    v_add_u32 v4, s48, v4
    v_add_u32 v5, s48, v5
    v_add_u32 v6, s48, v6
    v_mfma_f32_32x32x16_bf16 v[128:143], v[60:63], v[92:95], v[128:143]
    ds_read_b128 v[52:55], v3
    ds_read_b64_tr_b16 v[16:17], v2 offset:0
    ds_read_b64_tr_b16 v[18:19], v2 offset:2304
    v_mfma_f32_32x32x16_bf16 v[144:159], v[64:67], v[92:95], v[144:159]
    ds_read_b64_tr_b16 v[20:21], v2 offset:64
    ds_read_b64_tr_b16 v[22:23], v2 offset:2368
    ds_read_b64_tr_b16 v[24:25], v2 offset:128
    v_mfma_f32_32x32x16_bf16 v[160:175], v[68:71], v[92:95], v[160:175]
    ds_read_b64_tr_b16 v[26:27], v2 offset:2432
    ds_read_b64_tr_b16 v[28:29], v2 offset:192
    ds_read_b64_tr_b16 v[30:31], v2 offset:2496
    v_mfma_f32_32x32x16_bf16 v[176:191], v[72:75], v[92:95], v[176:191]
    ds_read_b64_tr_b16 v[32:33], v2 offset:256
    ds_read_b64_tr_b16 v[34:35], v2 offset:2560
    ds_read_b64_tr_b16 v[36:37], v2 offset:320
    v_mfma_f32_32x32x16_bf16 v[192:207], v[76:79], v[92:95], v[192:207]
    ds_read_b64_tr_b16 v[38:39], v2 offset:2624
    ds_read_b64_tr_b16 v[40:41], v2 offset:384
    ds_read_b64_tr_b16 v[42:43], v2 offset:2688
    v_mfma_f32_32x32x16_bf16 v[208:223], v[80:83], v[92:95], v[208:223]
    ds_read_b64_tr_b16 v[44:45], v2 offset:448
    ds_read_b64_tr_b16 v[46:47], v2 offset:2752
    ds_read_b64_tr_b16 v[48:49], v2 offset:512
    v_mfma_f32_32x32x16_bf16 v[224:239], v[84:87], v[92:95], v[224:239]
    ds_read_b64_tr_b16 v[50:51], v2 offset:2816
    s_sub_u32 s44, s44, 1
    s_cmp_lg_u32 s44, 0
    v_mfma_f32_32x32x16_bf16 v[240:255], v[88:91], v[92:95], v[240:255]
    s_cbranch_scc1 aw_aloop
    s_waitcnt lgkmcnt(0)
    v_mfma_f32_32x32x16_bf16 v[112:127], v[16:19], v[52:55], v[112:127]
    v_mfma_f32_32x32x16_bf16 v[128:143], v[20:23], v[52:55], v[128:143]
    v_mfma_f32_32x32x16_bf16 v[144:159], v[24:27], v[52:55], v[144:159]
    v_mfma_f32_32x32x16_bf16 v[160:175], v[28:31], v[52:55], v[160:175]
    v_mfma_f32_32x32x16_bf16 v[176:191], v[32:35], v[52:55], v[176:191]
    v_mfma_f32_32x32x16_bf16 v[192:207], v[36:39], v[52:55], v[192:207]
    v_mfma_f32_32x32x16_bf16 v[208:223], v[40:43], v[52:55], v[208:223]
    v_mfma_f32_32x32x16_bf16 v[224:239], v[44:47], v[52:55], v[224:239]
    v_mfma_f32_32x32x16_bf16 v[240:255], v[48:51], v[52:55], v[240:255]
aw_c_pad0:
    s_cbranch_execz aw_c_pad12
    s_barrier
    s_waitcnt vmcnt(0)
    s_nop 7
    s_nop 3
    v_cvt_pk_bf16_f32 v2, v248, v248
    s_mov_b32 s6, s4
    s_mov_b32 s7, s5
    s_add_u32 s6, s6, 16777216
    s_addc_u32 s7, s7, 0
    s_mov_b32 s20, s6
    s_and_b32 s21, s7, 0xffff
    s_mov_b32 s22, 2641920
    s_mov_b32 s23, 0x00020000
    s_lshl_b32 s56, s62, 1
    s_add_u32 s56, s56, s64
    s_mul_i32 s56, s56, 660480
    v_and_b32 v40, 31, v1
    s_lshl_b32 s48, s45, 5
    v_add_u32 v41, s48, v40
    s_lshl_b32 s57, s61, 8
    s_add_u32 s57, s57, s63
    v_lshlrev_b32 v41, 1, v41
    v_add_u32 v41, s57, v41
    v_mul_u32_u24 v41, 640, v41
    v_add_u32 v41, 512, v41
    v_cmp_gt_u32 vcc, 32, v1
    v_mov_b32 v42, 0x7ffffff0
    s_nop 0
    v_cndmask_b32 v41, v42, v41, vcc
    buffer_store_short v2, v41, s[20:23], s56 offen sc0 sc1
    v_cvt_pk_bf16_f32 v16, v112, v113
    v_cvt_pk_bf16_f32 v17, v114, v115
    v_cvt_pk_bf16_f32 v18, v116, v117
    v_cvt_pk_bf16_f32 v19, v118, v119
    v_cvt_pk_bf16_f32 v20, v120, v121
    v_cvt_pk_bf16_f32 v21, v122, v123
    v_cvt_pk_bf16_f32 v22, v124, v125
    v_cvt_pk_bf16_f32 v23, v126, v127
    v_permlane32_swap_b32 v16, v18
    v_permlane32_swap_b32 v17, v19
    v_cvt_pk_bf16_f32 v24, v128, v129
aw_c_pad1:
    s_cbranch_execz aw_c_pad13
    v_cvt_pk_bf16_f32 v25, v130, v131
    v_cvt_pk_bf16_f32 v26, v132, v133
    v_cvt_pk_bf16_f32 v27, v134, v135
    v_permlane32_swap_b32 v20, v22
    v_permlane32_swap_b32 v21, v23
    v_cvt_pk_bf16_f32 v28, v136, v137
    v_cvt_pk_bf16_f32 v29, v138, v139
    v_cvt_pk_bf16_f32 v30, v140, v141
    v_cvt_pk_bf16_f32 v31, v142, v143
    v_permlane32_swap_b32 v24, v26
    v_permlane32_swap_b32 v25, v27
    v_cvt_pk_bf16_f32 v32, v144, v145
    v_cvt_pk_bf16_f32 v33, v146, v147
    v_cvt_pk_bf16_f32 v34, v148, v149
    v_cvt_pk_bf16_f32 v35, v150, v151
    v_permlane32_swap_b32 v28, v30
    v_permlane32_swap_b32 v29, v31
    v_cvt_pk_bf16_f32 v36, v152, v153
    v_cvt_pk_bf16_f32 v37, v154, v155
    v_cvt_pk_bf16_f32 v38, v156, v157
    v_cvt_pk_bf16_f32 v39, v158, v159
    v_permlane32_swap_b32 v32, v34
    v_permlane32_swap_b32 v33, v35
    v_cvt_pk_bf16_f32 v40, v160, v161
    v_cvt_pk_bf16_f32 v41, v162, v163
    v_cvt_pk_bf16_f32 v42, v164, v165
    v_cvt_pk_bf16_f32 v43, v166, v167
    v_permlane32_swap_b32 v36, v38
    v_permlane32_swap_b32 v37, v39
    v_cvt_pk_bf16_f32 v44, v168, v169
    v_cvt_pk_bf16_f32 v45, v170, v171
    v_cvt_pk_bf16_f32 v46, v172, v173
    v_cvt_pk_bf16_f32 v47, v174, v175
    v_permlane32_swap_b32 v40, v42
    v_permlane32_swap_b32 v41, v43
    v_cvt_pk_bf16_f32 v48, v176, v177
    v_cvt_pk_bf16_f32 v49, v178, v179
    v_cvt_pk_bf16_f32 v50, v180, v181
    v_cvt_pk_bf16_f32 v51, v182, v183
    v_permlane32_swap_b32 v44, v46
    v_permlane32_swap_b32 v45, v47
aw_c_pad2:
    s_cbranch_execz aw_c_pad14
    v_cvt_pk_bf16_f32 v52, v184, v185
    v_cvt_pk_bf16_f32 v53, v186, v187
    v_cvt_pk_bf16_f32 v54, v188, v189
    v_cvt_pk_bf16_f32 v55, v190, v191
    v_permlane32_swap_b32 v48, v50
    v_permlane32_swap_b32 v49, v51
    v_cvt_pk_bf16_f32 v56, v192, v193
    v_cvt_pk_bf16_f32 v57, v194, v195
    v_cvt_pk_bf16_f32 v58, v196, v197
    v_cvt_pk_bf16_f32 v59, v198, v199
    v_permlane32_swap_b32 v52, v54
    v_permlane32_swap_b32 v53, v55
    v_cvt_pk_bf16_f32 v60, v200, v201
    v_cvt_pk_bf16_f32 v61, v202, v203
    v_cvt_pk_bf16_f32 v62, v204, v205
    v_cvt_pk_bf16_f32 v63, v206, v207
    v_permlane32_swap_b32 v56, v58
    v_permlane32_swap_b32 v57, v59
    v_cvt_pk_bf16_f32 v64, v208, v209
    v_cvt_pk_bf16_f32 v65, v210, v211
    v_cvt_pk_bf16_f32 v66, v212, v213
    v_cvt_pk_bf16_f32 v67, v214, v215
    v_permlane32_swap_b32 v60, v62
    v_permlane32_swap_b32 v61, v63
    v_cvt_pk_bf16_f32 v68, v216, v217
    v_cvt_pk_bf16_f32 v69, v218, v219
    v_cvt_pk_bf16_f32 v70, v220, v221
    v_cvt_pk_bf16_f32 v71, v222, v223
    v_permlane32_swap_b32 v64, v66
    v_permlane32_swap_b32 v65, v67
    v_cvt_pk_bf16_f32 v72, v224, v225
    v_cvt_pk_bf16_f32 v73, v226, v227
    v_cvt_pk_bf16_f32 v74, v228, v229
    v_cvt_pk_bf16_f32 v75, v230, v231
    v_permlane32_swap_b32 v68, v70
    v_permlane32_swap_b32 v69, v71
    v_cvt_pk_bf16_f32 v76, v232, v233
    v_cvt_pk_bf16_f32 v77, v234, v235
    v_cvt_pk_bf16_f32 v78, v236, v237
    v_cvt_pk_bf16_f32 v79, v238, v239
    v_permlane32_swap_b32 v72, v74
aw_c_pad3:
    s_cbranch_execz aw_cwret
    v_permlane32_swap_b32 v73, v75
    v_cvt_pk_bf16_f32 v80, v240, v241
    v_cvt_pk_bf16_f32 v81, v242, v243
    v_cvt_pk_bf16_f32 v82, v244, v245
    v_cvt_pk_bf16_f32 v83, v246, v247
    v_permlane32_swap_b32 v76, v78
    v_permlane32_swap_b32 v77, v79
    s_nop 1
    v_permlane32_swap_b32 v80, v82
    v_permlane32_swap_b32 v81, v83
    s_barrier
    v_and_b32 v4, 31, v1
    s_lshl_b32 s57, s45, 14
    v_lshlrev_b32 v3, 9, v4
    v_add_u32 v3, s57, v3
    v_lshrrev_b32 v5, 5, v1
    v_lshl_add_u32 v3, v5, 3, v3
    v_and_b32 v4, 7, v4
    v_lshl_add_u32 v3, v4, 4, v3
    ds_read_b128 v[84:87], v8 offset:0
    ds_read_b128 v[88:91], v8 offset:4096
    ds_read_b128 v[92:95], v8 offset:8192
    ds_read_b128 v[96:99], v8 offset:12288
    ds_read_b128 v[100:103], v9 offset:0
    ds_read_b128 v[104:107], v9 offset:4096
    ds_read_b128 v[108:111], v9 offset:8192
    ds_read_b128 v[112:115], v9 offset:12288
    s_waitcnt lgkmcnt(4)
    v_mfma_f32_32x32x16_bf16 v[128:143], v[84:87], v[16:19], 0
    ds_read_b128 v[116:119], v10 offset:0
    ds_read_b128 v[120:123], v10 offset:4096
    v_mfma_f32_32x32x16_bf16 v[144:159], v[88:91], v[16:19], 0
    ds_read_b128 v[124:127], v10 offset:8192
    ds_read_b128 v[12:15], v10 offset:12288
    v_mfma_f32_32x32x16_bf16 v[160:175], v[92:95], v[16:19], 0
    v_mfma_f32_32x32x16_bf16 v[176:191], v[96:99], v[16:19], 0
    s_waitcnt lgkmcnt(4)
    v_mfma_f32_32x32x16_bf16 v[128:143], v[100:103], v[20:23], v[128:143]
    ds_read_b128 v[84:87], v11 offset:0
    ds_read_b128 v[88:91], v11 offset:4096
    v_mfma_f32_32x32x16_bf16 v[144:159], v[104:107], v[20:23], v[144:159]
aw_c_pad4:
    s_cbranch_execz aw_cwret
    ds_read_b128 v[92:95], v11 offset:8192
    ds_read_b128 v[96:99], v11 offset:12288
    v_mfma_f32_32x32x16_bf16 v[160:175], v[108:111], v[20:23], v[160:175]
    v_mfma_f32_32x32x16_bf16 v[176:191], v[112:115], v[20:23], v[176:191]
    s_waitcnt lgkmcnt(4)
    v_mfma_f32_32x32x16_bf16 v[128:143], v[116:119], v[24:27], v[128:143]
    ds_read_b128 v[100:103], v8 offset:16384
    ds_read_b128 v[104:107], v8 offset:20480
    v_mfma_f32_32x32x16_bf16 v[144:159], v[120:123], v[24:27], v[144:159]
    ds_read_b128 v[108:111], v8 offset:24576
    ds_read_b128 v[112:115], v8 offset:28672
    v_mfma_f32_32x32x16_bf16 v[160:175], v[124:127], v[24:27], v[160:175]
    v_mfma_f32_32x32x16_bf16 v[176:191], v[12:15], v[24:27], v[176:191]
    s_waitcnt lgkmcnt(4)
    v_mfma_f32_32x32x16_bf16 v[128:143], v[84:87], v[28:31], v[128:143]
    ds_read_b128 v[116:119], v9 offset:16384
    ds_read_b128 v[120:123], v9 offset:20480
    v_mfma_f32_32x32x16_bf16 v[144:159], v[88:91], v[28:31], v[144:159]
    ds_read_b128 v[124:127], v9 offset:24576
    ds_read_b128 v[12:15], v9 offset:28672
    v_mfma_f32_32x32x16_bf16 v[160:175], v[92:95], v[28:31], v[160:175]
    v_mfma_f32_32x32x16_bf16 v[176:191], v[96:99], v[28:31], v[176:191]
    s_waitcnt lgkmcnt(4)
    v_mfma_f32_32x32x16_bf16 v[128:143], v[100:103], v[32:35], v[128:143]
    ds_read_b128 v[84:87], v10 offset:16384
    ds_read_b128 v[88:91], v10 offset:20480
    v_mfma_f32_32x32x16_bf16 v[144:159], v[104:107], v[32:35], v[144:159]
    ds_read_b128 v[92:95], v10 offset:24576
    ds_read_b128 v[96:99], v10 offset:28672
    v_mfma_f32_32x32x16_bf16 v[160:175], v[108:111], v[32:35], v[160:175]
    v_mfma_f32_32x32x16_bf16 v[176:191], v[112:115], v[32:35], v[176:191]
    s_waitcnt lgkmcnt(4)
    v_mfma_f32_32x32x16_bf16 v[128:143], v[116:119], v[36:39], v[128:143]
    ds_read_b128 v[100:103], v11 offset:16384
    ds_read_b128 v[104:107], v11 offset:20480
    v_mfma_f32_32x32x16_bf16 v[144:159], v[120:123], v[36:39], v[144:159]
    ds_read_b128 v[108:111], v11 offset:24576
    ds_read_b128 v[112:115], v11 offset:28672
    v_mfma_f32_32x32x16_bf16 v[160:175], v[124:127], v[36:39], v[160:175]
    v_mfma_f32_32x32x16_bf16 v[176:191], v[12:15], v[36:39], v[176:191]
    s_waitcnt lgkmcnt(4)
aw_c_pad5:
    s_cbranch_execz aw_cwret
    v_mfma_f32_32x32x16_bf16 v[128:143], v[84:87], v[40:43], v[128:143]
    ds_read_b128 v[116:119], v8 offset:32768
    ds_read_b128 v[120:123], v8 offset:36864
    v_mfma_f32_32x32x16_bf16 v[144:159], v[88:91], v[40:43], v[144:159]
    ds_read_b128 v[124:127], v8 offset:40960
    ds_read_b128 v[12:15], v8 offset:45056
    v_mfma_f32_32x32x16_bf16 v[160:175], v[92:95], v[40:43], v[160:175]
    v_mfma_f32_32x32x16_bf16 v[176:191], v[96:99], v[40:43], v[176:191]
    s_waitcnt lgkmcnt(4)
    v_mfma_f32_32x32x16_bf16 v[128:143], v[100:103], v[44:47], v[128:143]
    ds_read_b128 v[84:87], v9 offset:32768
    ds_read_b128 v[88:91], v9 offset:36864
    v_mfma_f32_32x32x16_bf16 v[144:159], v[104:107], v[44:47], v[144:159]
    ds_read_b128 v[92:95], v9 offset:40960
    ds_read_b128 v[96:99], v9 offset:45056
    v_mfma_f32_32x32x16_bf16 v[160:175], v[108:111], v[44:47], v[160:175]
    v_mfma_f32_32x32x16_bf16 v[176:191], v[112:115], v[44:47], v[176:191]
    s_waitcnt lgkmcnt(4)
    v_mfma_f32_32x32x16_bf16 v[128:143], v[116:119], v[48:51], v[128:143]
    ds_read_b128 v[100:103], v10 offset:32768
    ds_read_b128 v[104:107], v10 offset:36864
    v_mfma_f32_32x32x16_bf16 v[144:159], v[120:123], v[48:51], v[144:159]
    ds_read_b128 v[108:111], v10 offset:40960
    ds_read_b128 v[112:115], v10 offset:45056
    v_mfma_f32_32x32x16_bf16 v[160:175], v[124:127], v[48:51], v[160:175]
    v_mfma_f32_32x32x16_bf16 v[176:191], v[12:15], v[48:51], v[176:191]
    s_waitcnt lgkmcnt(4)
    v_mfma_f32_32x32x16_bf16 v[128:143], v[84:87], v[52:55], v[128:143]
    ds_read_b128 v[116:119], v11 offset:32768
    ds_read_b128 v[120:123], v11 offset:36864
    v_mfma_f32_32x32x16_bf16 v[144:159], v[88:91], v[52:55], v[144:159]
    ds_read_b128 v[124:127], v11 offset:40960
    ds_read_b128 v[12:15], v11 offset:45056
    v_mfma_f32_32x32x16_bf16 v[160:175], v[92:95], v[52:55], v[160:175]
    v_mfma_f32_32x32x16_bf16 v[176:191], v[96:99], v[52:55], v[176:191]
    s_waitcnt lgkmcnt(4)
    v_mfma_f32_32x32x16_bf16 v[128:143], v[100:103], v[56:59], v[128:143]
    v_add_u32 v8, 49152, v8
    v_add_u32 v9, 49152, v9
    v_mfma_f32_32x32x16_bf16 v[144:159], v[104:107], v[56:59], v[144:159]
    v_add_u32 v10, 49152, v10
aw_c_pad6:
    s_cbranch_execz aw_cwret
    v_add_u32 v11, 49152, v11
    v_mfma_f32_32x32x16_bf16 v[160:175], v[108:111], v[56:59], v[160:175]
    ds_read_b128 v[84:87], v8 offset:0
    ds_read_b128 v[88:91], v8 offset:4096
    v_mfma_f32_32x32x16_bf16 v[176:191], v[112:115], v[56:59], v[176:191]
    ds_read_b128 v[92:95], v8 offset:8192
    ds_read_b128 v[96:99], v8 offset:12288
    s_waitcnt lgkmcnt(4)
    v_mfma_f32_32x32x16_bf16 v[128:143], v[116:119], v[60:63], v[128:143]
    ds_read_b128 v[100:103], v9 offset:0
    ds_read_b128 v[104:107], v9 offset:4096
    v_mfma_f32_32x32x16_bf16 v[144:159], v[120:123], v[60:63], v[144:159]
    ds_read_b128 v[108:111], v9 offset:8192
    ds_read_b128 v[112:115], v9 offset:12288
    v_mfma_f32_32x32x16_bf16 v[160:175], v[124:127], v[60:63], v[160:175]
    v_mfma_f32_32x32x16_bf16 v[176:191], v[12:15], v[60:63], v[176:191]
    s_waitcnt lgkmcnt(4)
    v_mfma_f32_32x32x16_bf16 v[128:143], v[84:87], v[64:67], v[128:143]
    ds_read_b128 v[116:119], v10 offset:0
    ds_read_b128 v[120:123], v10 offset:4096
    v_mfma_f32_32x32x16_bf16 v[144:159], v[88:91], v[64:67], v[144:159]
    ds_read_b128 v[124:127], v10 offset:8192
    ds_read_b128 v[12:15], v10 offset:12288
    v_mfma_f32_32x32x16_bf16 v[160:175], v[92:95], v[64:67], v[160:175]
    v_mfma_f32_32x32x16_bf16 v[176:191], v[96:99], v[64:67], v[176:191]
    s_waitcnt lgkmcnt(4)
    v_mfma_f32_32x32x16_bf16 v[128:143], v[100:103], v[68:71], v[128:143]
    ds_read_b128 v[84:87], v11 offset:0
    ds_read_b128 v[88:91], v11 offset:4096
    v_mfma_f32_32x32x16_bf16 v[144:159], v[104:107], v[68:71], v[144:159]
    ds_read_b128 v[92:95], v11 offset:8192
    ds_read_b128 v[96:99], v11 offset:12288
    v_mfma_f32_32x32x16_bf16 v[160:175], v[108:111], v[68:71], v[160:175]
    v_mfma_f32_32x32x16_bf16 v[176:191], v[112:115], v[68:71], v[176:191]
    s_waitcnt lgkmcnt(4)
    v_mfma_f32_32x32x16_bf16 v[128:143], v[116:119], v[72:75], v[128:143]
    ds_read_b128 v[100:103], v7 offset:0
    ds_read_b128 v[104:107], v7 offset:1024
    v_mfma_f32_32x32x16_bf16 v[144:159], v[120:123], v[72:75], v[144:159]
    ds_read_b128 v[108:111], v7 offset:2048
    ds_read_b128 v[112:115], v7 offset:3072
aw_c_pad7:
    s_cbranch_execz aw_cwret
    v_mfma_f32_32x32x16_bf16 v[160:175], v[124:127], v[72:75], v[160:175]
    v_mfma_f32_32x32x16_bf16 v[176:191], v[12:15], v[72:75], v[176:191]
    s_waitcnt lgkmcnt(4)
    s_barrier
    v_mfma_f32_32x32x16_bf16 v[128:143], v[84:87], v[76:79], v[128:143]
    ds_read_b128 v[116:119], v8 offset:16384
    ds_read_b128 v[120:123], v8 offset:20480
    v_mfma_f32_32x32x16_bf16 v[144:159], v[88:91], v[76:79], v[144:159]
    ds_read_b128 v[124:127], v8 offset:24576
    ds_read_b128 v[12:15], v8 offset:28672
    v_mfma_f32_32x32x16_bf16 v[160:175], v[92:95], v[76:79], v[160:175]
    v_mfma_f32_32x32x16_bf16 v[176:191], v[96:99], v[76:79], v[176:191]
    s_waitcnt lgkmcnt(4)
    v_mfma_f32_32x32x16_bf16 v[128:143], v[100:103], v[80:83], v[128:143]
    ds_read_b128 v[84:87], v9 offset:16384
    ds_read_b128 v[88:91], v9 offset:20480
    v_mfma_f32_32x32x16_bf16 v[144:159], v[104:107], v[80:83], v[144:159]
    ds_read_b128 v[92:95], v9 offset:24576
    ds_read_b128 v[96:99], v9 offset:28672
    v_mfma_f32_32x32x16_bf16 v[160:175], v[108:111], v[80:83], v[160:175]
    v_mfma_f32_32x32x16_bf16 v[176:191], v[112:115], v[80:83], v[176:191]
    s_waitcnt lgkmcnt(4)
    v_mfma_f32_32x32x16_bf16 v[192:207], v[116:119], v[16:19], 0
    ds_read_b128 v[100:103], v10 offset:16384
    ds_read_b128 v[104:107], v10 offset:20480
    ds_read_b128 v[108:111], v10 offset:24576
    ds_read_b128 v[112:115], v10 offset:28672
    v_mfma_f32_32x32x16_bf16 v[208:223], v[120:123], v[16:19], 0
    v_cvt_pk_bf16_f32 v4, v128, v129
    v_cvt_pk_bf16_f32 v5, v130, v131
    v_xor_b32 v6, 0, v3
    ds_write_b64 v6, v[4:5] offset:0
    v_mfma_f32_32x32x16_bf16 v[224:239], v[124:127], v[16:19], 0
    v_cvt_pk_bf16_f32 v4, v132, v133
    v_cvt_pk_bf16_f32 v5, v134, v135
    v_xor_b32 v6, 16, v3
    ds_write_b64 v6, v[4:5] offset:0
    v_mfma_f32_32x32x16_bf16 v[240:255], v[12:15], v[16:19], 0
    s_waitcnt lgkmcnt(6)
    v_mfma_f32_32x32x16_bf16 v[192:207], v[84:87], v[20:23], v[192:207]
    ds_read_b128 v[116:119], v11 offset:16384
aw_c_pad8:
    s_cbranch_execz aw_cwret
    ds_read_b128 v[120:123], v11 offset:20480
    ds_read_b128 v[124:127], v11 offset:24576
    ds_read_b128 v[12:15], v11 offset:28672
    v_mfma_f32_32x32x16_bf16 v[208:223], v[88:91], v[20:23], v[208:223]
    v_cvt_pk_bf16_f32 v4, v136, v137
    v_cvt_pk_bf16_f32 v5, v138, v139
    v_xor_b32 v6, 32, v3
    ds_write_b64 v6, v[4:5] offset:0
    v_mfma_f32_32x32x16_bf16 v[224:239], v[92:95], v[20:23], v[224:239]
    v_cvt_pk_bf16_f32 v4, v140, v141
    v_cvt_pk_bf16_f32 v5, v142, v143
    v_xor_b32 v6, 48, v3
    ds_write_b64 v6, v[4:5] offset:0
    v_mfma_f32_32x32x16_bf16 v[240:255], v[96:99], v[20:23], v[240:255]
    s_waitcnt lgkmcnt(8)
    v_mfma_f32_32x32x16_bf16 v[192:207], v[100:103], v[24:27], v[192:207]
    ds_read_b128 v[84:87], v8 offset:32768
    ds_read_b128 v[88:91], v8 offset:36864
    ds_read_b128 v[92:95], v8 offset:40960
    ds_read_b128 v[96:99], v8 offset:45056
    v_mfma_f32_32x32x16_bf16 v[208:223], v[104:107], v[24:27], v[208:223]
    v_cvt_pk_bf16_f32 v4, v144, v145
    v_cvt_pk_bf16_f32 v5, v146, v147
    v_xor_b32 v6, 64, v3
    ds_write_b64 v6, v[4:5] offset:0
    v_mfma_f32_32x32x16_bf16 v[224:239], v[108:111], v[24:27], v[224:239]
    v_cvt_pk_bf16_f32 v4, v148, v149
    v_cvt_pk_bf16_f32 v5, v150, v151
    v_xor_b32 v6, 80, v3
    ds_write_b64 v6, v[4:5] offset:0
    v_mfma_f32_32x32x16_bf16 v[240:255], v[112:115], v[24:27], v[240:255]
    s_waitcnt lgkmcnt(8)
    v_mfma_f32_32x32x16_bf16 v[192:207], v[116:119], v[28:31], v[192:207]
    ds_read_b128 v[100:103], v9 offset:32768
    ds_read_b128 v[104:107], v9 offset:36864
    ds_read_b128 v[108:111], v9 offset:40960
    ds_read_b128 v[112:115], v9 offset:45056
    v_mfma_f32_32x32x16_bf16 v[208:223], v[120:123], v[28:31], v[208:223]
    v_cvt_pk_bf16_f32 v4, v152, v153
    v_cvt_pk_bf16_f32 v5, v154, v155
    v_xor_b32 v6, 96, v3
aw_c_pad9:
    s_cbranch_execz aw_cwret
    ds_write_b64 v6, v[4:5] offset:0
    v_mfma_f32_32x32x16_bf16 v[224:239], v[124:127], v[28:31], v[224:239]
    v_cvt_pk_bf16_f32 v4, v156, v157
    v_cvt_pk_bf16_f32 v5, v158, v159
    v_xor_b32 v6, 112, v3
    ds_write_b64 v6, v[4:5] offset:0
    v_mfma_f32_32x32x16_bf16 v[240:255], v[12:15], v[28:31], v[240:255]
    s_waitcnt lgkmcnt(8)
    v_mfma_f32_32x32x16_bf16 v[192:207], v[84:87], v[32:35], v[192:207]
    ds_read_b128 v[116:119], v10 offset:32768
    ds_read_b128 v[120:123], v10 offset:36864
    ds_read_b128 v[124:127], v10 offset:40960
    ds_read_b128 v[12:15], v10 offset:45056
    v_mfma_f32_32x32x16_bf16 v[208:223], v[88:91], v[32:35], v[208:223]
    v_cvt_pk_bf16_f32 v4, v160, v161
    v_cvt_pk_bf16_f32 v5, v162, v163
    v_xor_b32 v6, 0, v3
    ds_write_b64 v6, v[4:5] offset:128
    v_mfma_f32_32x32x16_bf16 v[224:239], v[92:95], v[32:35], v[224:239]
    v_cvt_pk_bf16_f32 v4, v164, v165
    v_cvt_pk_bf16_f32 v5, v166, v167
    v_xor_b32 v6, 16, v3
    ds_write_b64 v6, v[4:5] offset:128
    v_mfma_f32_32x32x16_bf16 v[240:255], v[96:99], v[32:35], v[240:255]
    s_waitcnt lgkmcnt(8)
    v_mfma_f32_32x32x16_bf16 v[192:207], v[100:103], v[36:39], v[192:207]
    ds_read_b128 v[84:87], v11 offset:32768
    ds_read_b128 v[88:91], v11 offset:36864
    ds_read_b128 v[92:95], v11 offset:40960
    ds_read_b128 v[96:99], v11 offset:45056
    v_mfma_f32_32x32x16_bf16 v[208:223], v[104:107], v[36:39], v[208:223]
    v_cvt_pk_bf16_f32 v4, v168, v169
    v_cvt_pk_bf16_f32 v5, v170, v171
    v_xor_b32 v6, 32, v3
    ds_write_b64 v6, v[4:5] offset:128
    v_mfma_f32_32x32x16_bf16 v[224:239], v[108:111], v[36:39], v[224:239]
    v_cvt_pk_bf16_f32 v4, v172, v173
    v_cvt_pk_bf16_f32 v5, v174, v175
    v_xor_b32 v6, 48, v3
    ds_write_b64 v6, v[4:5] offset:128
    v_mfma_f32_32x32x16_bf16 v[240:255], v[112:115], v[36:39], v[240:255]
aw_c_pad10:
    s_cbranch_execz aw_cwret
    s_waitcnt lgkmcnt(8)
    v_mfma_f32_32x32x16_bf16 v[192:207], v[116:119], v[40:43], v[192:207]
    v_add_u32 v8, 49152, v8
    v_add_u32 v9, 49152, v9
    v_add_u32 v10, 49152, v10
    v_add_u32 v11, 49152, v11
    v_mfma_f32_32x32x16_bf16 v[208:223], v[120:123], v[40:43], v[208:223]
    ds_read_b128 v[100:103], v8 offset:0
    ds_read_b128 v[104:107], v8 offset:4096
    ds_read_b128 v[108:111], v8 offset:8192
    ds_read_b128 v[112:115], v8 offset:12288
    v_mfma_f32_32x32x16_bf16 v[224:239], v[124:127], v[40:43], v[224:239]
    v_cvt_pk_bf16_f32 v4, v176, v177
    v_cvt_pk_bf16_f32 v5, v178, v179
    v_xor_b32 v6, 64, v3
    ds_write_b64 v6, v[4:5] offset:128
    v_mfma_f32_32x32x16_bf16 v[240:255], v[12:15], v[40:43], v[240:255]
    v_cvt_pk_bf16_f32 v4, v180, v181
    v_cvt_pk_bf16_f32 v5, v182, v183
    v_xor_b32 v6, 80, v3
    ds_write_b64 v6, v[4:5] offset:128
    s_waitcnt lgkmcnt(8)
    v_mfma_f32_32x32x16_bf16 v[192:207], v[84:87], v[44:47], v[192:207]
    ds_read_b128 v[116:119], v9 offset:0
    ds_read_b128 v[120:123], v9 offset:4096
    ds_read_b128 v[124:127], v9 offset:8192
    ds_read_b128 v[12:15], v9 offset:12288
    v_mfma_f32_32x32x16_bf16 v[208:223], v[88:91], v[44:47], v[208:223]
    v_cvt_pk_bf16_f32 v4, v184, v185
    v_cvt_pk_bf16_f32 v5, v186, v187
    v_xor_b32 v6, 96, v3
    ds_write_b64 v6, v[4:5] offset:128
    v_mfma_f32_32x32x16_bf16 v[224:239], v[92:95], v[44:47], v[224:239]
    v_cvt_pk_bf16_f32 v4, v188, v189
    v_cvt_pk_bf16_f32 v5, v190, v191
    v_xor_b32 v6, 112, v3
    ds_write_b64 v6, v[4:5] offset:128
    v_mfma_f32_32x32x16_bf16 v[240:255], v[96:99], v[44:47], v[240:255]
    s_waitcnt lgkmcnt(8)
    s_waitcnt lgkmcnt(0)
    s_barrier
aw_c_pad11:
    s_cbranch_execz aw_cwret
    v_mfma_f32_32x32x16_bf16 v[192:207], v[100:103], v[48:51], v[192:207]
    ds_read_b128 v[84:87], v10 offset:0
    ds_read_b128 v[88:91], v10 offset:4096
    v_mfma_f32_32x32x16_bf16 v[208:223], v[104:107], v[48:51], v[208:223]
    ds_read_b128 v[92:95], v10 offset:8192
    ds_read_b128 v[96:99], v10 offset:12288
    v_mfma_f32_32x32x16_bf16 v[224:239], v[108:111], v[48:51], v[224:239]
    v_mfma_f32_32x32x16_bf16 v[240:255], v[112:115], v[48:51], v[240:255]
    v_mfma_f32_32x32x16_bf16 v[192:207], v[116:119], v[52:55], v[192:207]
    ds_read_b128 v[100:103], v11 offset:0
    ds_read_b128 v[104:107], v11 offset:4096
    v_mfma_f32_32x32x16_bf16 v[208:223], v[120:123], v[52:55], v[208:223]
    ds_read_b128 v[108:111], v11 offset:8192
    ds_read_b128 v[112:115], v11 offset:12288
    v_mfma_f32_32x32x16_bf16 v[224:239], v[124:127], v[52:55], v[224:239]
    v_mfma_f32_32x32x16_bf16 v[240:255], v[12:15], v[52:55], v[240:255]
    s_waitcnt lgkmcnt(4)
    v_mfma_f32_32x32x16_bf16 v[192:207], v[84:87], v[56:59], v[192:207]
    ds_read_b128 v[116:119], v8 offset:16384
    ds_read_b128 v[120:123], v8 offset:20480
    v_mfma_f32_32x32x16_bf16 v[208:223], v[88:91], v[56:59], v[208:223]
    ds_read_b128 v[124:127], v8 offset:24576
    ds_read_b128 v[12:15], v8 offset:28672
    v_mfma_f32_32x32x16_bf16 v[224:239], v[92:95], v[56:59], v[224:239]
    v_mfma_f32_32x32x16_bf16 v[240:255], v[96:99], v[56:59], v[240:255]
    s_waitcnt lgkmcnt(4)
    v_mfma_f32_32x32x16_bf16 v[192:207], v[100:103], v[60:63], v[192:207]
    ds_read_b128 v[84:87], v9 offset:16384
    ds_read_b128 v[88:91], v9 offset:20480
    v_mfma_f32_32x32x16_bf16 v[208:223], v[104:107], v[60:63], v[208:223]
    ds_read_b128 v[92:95], v9 offset:24576
    ds_read_b128 v[96:99], v9 offset:28672
    v_mfma_f32_32x32x16_bf16 v[224:239], v[108:111], v[60:63], v[224:239]
    v_mfma_f32_32x32x16_bf16 v[240:255], v[112:115], v[60:63], v[240:255]
    s_waitcnt lgkmcnt(4)
    v_mfma_f32_32x32x16_bf16 v[192:207], v[116:119], v[64:67], v[192:207]
    ds_read_b128 v[100:103], v10 offset:16384
    ds_read_b128 v[104:107], v10 offset:20480
    v_mfma_f32_32x32x16_bf16 v[208:223], v[120:123], v[64:67], v[208:223]
    ds_read_b128 v[108:111], v10 offset:24576
    ds_read_b128 v[112:115], v10 offset:28672
aw_c_pad12:
    s_cbranch_execz aw_cwret
    v_mfma_f32_32x32x16_bf16 v[224:239], v[124:127], v[64:67], v[224:239]
    v_mfma_f32_32x32x16_bf16 v[240:255], v[12:15], v[64:67], v[240:255]
    s_waitcnt lgkmcnt(4)
    v_mfma_f32_32x32x16_bf16 v[192:207], v[84:87], v[68:71], v[192:207]
    ds_read_b128 v[116:119], v11 offset:16384
    ds_read_b128 v[120:123], v11 offset:20480
    v_mfma_f32_32x32x16_bf16 v[208:223], v[88:91], v[68:71], v[208:223]
    ds_read_b128 v[124:127], v11 offset:24576
    ds_read_b128 v[12:15], v11 offset:28672
    v_mfma_f32_32x32x16_bf16 v[224:239], v[92:95], v[68:71], v[224:239]
    v_mfma_f32_32x32x16_bf16 v[240:255], v[96:99], v[68:71], v[240:255]
    s_waitcnt lgkmcnt(4)
    v_mfma_f32_32x32x16_bf16 v[192:207], v[100:103], v[72:75], v[192:207]
    ds_read_b128 v[84:87], v7 offset:4096
    ds_read_b128 v[88:91], v7 offset:5120
    v_mfma_f32_32x32x16_bf16 v[208:223], v[104:107], v[72:75], v[208:223]
    ds_read_b128 v[92:95], v7 offset:6144
    ds_read_b128 v[96:99], v7 offset:7168
    v_mfma_f32_32x32x16_bf16 v[224:239], v[108:111], v[72:75], v[224:239]
    v_mfma_f32_32x32x16_bf16 v[240:255], v[112:115], v[72:75], v[240:255]
    s_waitcnt lgkmcnt(4)
    v_mfma_f32_32x32x16_bf16 v[192:207], v[116:119], v[76:79], v[192:207]
    v_mfma_f32_32x32x16_bf16 v[208:223], v[120:123], v[76:79], v[208:223]
    v_mfma_f32_32x32x16_bf16 v[224:239], v[124:127], v[76:79], v[224:239]
    v_mfma_f32_32x32x16_bf16 v[240:255], v[12:15], v[76:79], v[240:255]
    s_waitcnt lgkmcnt(0)
    v_mfma_f32_32x32x16_bf16 v[192:207], v[84:87], v[80:83], v[192:207]
    v_mfma_f32_32x32x16_bf16 v[208:223], v[88:91], v[80:83], v[208:223]
    v_mfma_f32_32x32x16_bf16 v[224:239], v[92:95], v[80:83], v[224:239]
    v_mfma_f32_32x32x16_bf16 v[240:255], v[96:99], v[80:83], v[240:255]
    s_nop 7
    s_nop 3
    v_cvt_pk_bf16_f32 v4, v192, v193
    v_cvt_pk_bf16_f32 v5, v194, v195
    v_xor_b32 v6, 0, v3
    ds_write_b64 v6, v[4:5] offset:256
    v_cvt_pk_bf16_f32 v4, v196, v197
    v_cvt_pk_bf16_f32 v5, v198, v199
    v_xor_b32 v6, 16, v3
    ds_write_b64 v6, v[4:5] offset:256
    v_cvt_pk_bf16_f32 v4, v200, v201
aw_c_pad13:
    s_cbranch_execz aw_cwret
    v_cvt_pk_bf16_f32 v5, v202, v203
    v_xor_b32 v6, 32, v3
    ds_write_b64 v6, v[4:5] offset:256
    v_cvt_pk_bf16_f32 v4, v204, v205
    v_cvt_pk_bf16_f32 v5, v206, v207
    v_xor_b32 v6, 48, v3
    ds_write_b64 v6, v[4:5] offset:256
    v_cvt_pk_bf16_f32 v4, v208, v209
    v_cvt_pk_bf16_f32 v5, v210, v211
    v_xor_b32 v6, 64, v3
    ds_write_b64 v6, v[4:5] offset:256
    v_cvt_pk_bf16_f32 v4, v212, v213
    v_cvt_pk_bf16_f32 v5, v214, v215
    v_xor_b32 v6, 80, v3
    ds_write_b64 v6, v[4:5] offset:256
    v_cvt_pk_bf16_f32 v4, v216, v217
    v_cvt_pk_bf16_f32 v5, v218, v219
    v_xor_b32 v6, 96, v3
    ds_write_b64 v6, v[4:5] offset:256
    v_cvt_pk_bf16_f32 v4, v220, v221
    v_cvt_pk_bf16_f32 v5, v222, v223
    v_xor_b32 v6, 112, v3
    ds_write_b64 v6, v[4:5] offset:256
    v_cvt_pk_bf16_f32 v4, v224, v225
    v_cvt_pk_bf16_f32 v5, v226, v227
    v_xor_b32 v6, 0, v3
    ds_write_b64 v6, v[4:5] offset:384
    v_cvt_pk_bf16_f32 v4, v228, v229
    v_cvt_pk_bf16_f32 v5, v230, v231
    v_xor_b32 v6, 16, v3
    ds_write_b64 v6, v[4:5] offset:384
    v_cvt_pk_bf16_f32 v4, v232, v233
    v_cvt_pk_bf16_f32 v5, v234, v235
    v_xor_b32 v6, 32, v3
    ds_write_b64 v6, v[4:5] offset:384
    v_cvt_pk_bf16_f32 v4, v236, v237
    v_cvt_pk_bf16_f32 v5, v238, v239
    v_xor_b32 v6, 48, v3
    ds_write_b64 v6, v[4:5] offset:384
    v_cvt_pk_bf16_f32 v4, v240, v241
    v_cvt_pk_bf16_f32 v5, v242, v243
aw_c_pad14:
    s_cbranch_execz aw_cwret
    v_xor_b32 v6, 64, v3
    ds_write_b64 v6, v[4:5] offset:384
    v_cvt_pk_bf16_f32 v4, v244, v245
    v_cvt_pk_bf16_f32 v5, v246, v247
    v_xor_b32 v6, 80, v3
    ds_write_b64 v6, v[4:5] offset:384
    v_cvt_pk_bf16_f32 v4, v248, v249
    v_cvt_pk_bf16_f32 v5, v250, v251
    v_xor_b32 v6, 96, v3
    ds_write_b64 v6, v[4:5] offset:384
    v_cvt_pk_bf16_f32 v4, v252, v253
    v_cvt_pk_bf16_f32 v5, v254, v255
    v_xor_b32 v6, 112, v3
    ds_write_b64 v6, v[4:5] offset:384
    s_waitcnt lgkmcnt(0)
    s_barrier
    s_branch f_cp
aw_chk:
    s_mov_b32 s68, 0
    s_waitcnt vmcnt(0)
    v_xor_b32 v96, s66, v96
    v_xor_b32 v97, s66, v97
    v_xor_b32 v98, s66, v98
    v_xor_b32 v99, s66, v99
    v_or_b32 v96, v96, v97
    v_or_b32 v98, v98, v99
    v_or_b32 v96, v96, v98
    v_cmp_ne_u32 s[56:57], 0, v96
    s_nop 4
    s_mov_b32 s69, 0x8000
pc_51:
    s_and_b32 s58, s57, 1
    s_or_b32 s58, s58, s56
    s_cbranch_scc0 pd_52
    s_sub_u32 s69, s69, 1
    s_cbranch_scc1 pd_52
    buffer_load_dwordx4 v[96:99], v101, s[92:95], 0 offen sc1
    s_waitcnt vmcnt(0)
    v_xor_b32 v96, s66, v96
    v_xor_b32 v97, s66, v97
    v_xor_b32 v98, s66, v98
    v_xor_b32 v99, s66, v99
    v_or_b32 v96, v96, v97
    v_or_b32 v98, v98, v99
    v_or_b32 v96, v96, v98
    v_cmp_ne_u32 s[56:57], 0, v96
    s_nop 4
    s_branch pc_51
pd_52:
    s_branch aw_chkret
f_ld:
    s_load_dwordx2 s[6:7], s[0:1], 64
    s_load_dwordx2 s[20:21], s[0:1], 72
    s_load_dwordx2 s[22:23], s[0:1], 88
    s_load_dwordx2 s[4:5], s[0:1], 104
    s_load_dwordx2 s[62:63], s[0:1], 96
    s_lshr_b32 s27, s2, 3
    s_bfe_u32 s67, s2, 0x10001
    s_bfe_u32 s28, s2, 0x10002
    s_lshl_b32 s28, s28, 3
    s_lshr_b32 s30, s27, 2
    s_add_u32 s28, s28, s30
    s_and_b32 s29, s2, 1
    s_lshl_b32 s29, s29, 2
    s_and_b32 s30, s27, 3
    s_add_u32 s29, s29, s30
    s_mul_i32 s40, s28, 950272
    s_mul_i32 s30, s67, 3584
    s_add_u32 s40, s40, s30
    s_mul_i32 s41, s29, 256
    s_mul_i32 s30, s67, 3670016
    s_add_u32 s41, s41, s30
    s_and_b32 s30, s2, 1
    s_mul_i32 s31, s30, 1792
    s_add_u32 s40, s40, s31
    s_mul_i32 s31, s30, 1835008
    s_add_u32 s41, s41, s31
    s_and_b32 s31, s45, 1
    s_lshl_b32 s31, s31, 6
    s_lshl_b32 s30, s28, 7
    s_add_u32 s30, s30, s31
    s_lshl_b32 s31, s67, 5
    s_add_u32 s30, s30, s31
    s_bfe_u32 s31, s45, 0x10001
    s_lshl_b32 s31, s31, 7
    s_lshl_b32 s66, s29, 8
    s_add_u32 s31, s31, s66
    v_lshrrev_b32 v40, 3, v1
    v_lshrrev_b32 v41, 4, v1
    v_and_b32 v42, 7, v1
    v_mul_u32_u24 v43, 7424, v40
    v_xor_b32 v42, v42, v41
    v_lshl_add_u32 v43, v42, 4, v43
    v_xor_b32 v44, 64, v43
    s_mul_i32 s46, s45, 1
    s_add_u32 s46, s46, 0
    s_lshr_b32 s47, s46, 1
    s_lshl_b32 s47, s47, 1
    s_add_u32 s46, s46, s67
    s_and_b32 s46, s46, 1
    s_add_u32 s46, s46, s47
    s_mul_i32 s46, s46, 237568
    v_add_u32 v2, 0, v43
    v_add_u32 v2, s46, v2
    v_add_u32 v3, 58368, v44
    v_add_u32 v3, s46, v3
    v_add_u32 v4, 116736, v43
    v_add_u32 v4, s46, v4
    v_add_u32 v5, 175104, v44
    v_add_u32 v5, s46, v5
    s_mul_i32 s46, s45, 32768
    v_and_b32 v42, 15, v1
    v_lshlrev_b32 v45, 2, v41
    v_xor_b32 v42, v42, v45
    v_mul_u32_u24 v43, 2048, v41
    v_add_u32 v43, s46, v43
    v_lshl_add_u32 v43, v42, 4, v43
    v_xor_b32 v44, 32, v43
    v_add_u32 v6, 0, v43
    v_add_u32 v7, 7168, v43
    v_add_u32 v8, 14336, v44
    v_add_u32 v9, 21504, v44
    s_mul_i32 s50, s45, 4096
    s_mul_i32 s51, s45, 4096
    s_add_u32 s51, s51, 16384
    s_mov_b32 s43, 0
    s_waitcnt lgkmcnt(0)
    s_mov_b32 s12, s6
    s_and_b32 s13, s7, 0xffff
    s_mov_b32 s14, 7340032
    s_mov_b32 s15, 0x00020000
    s_mov_b32 s8, s4
    s_and_b32 s9, s5, 0xffff
    s_mov_b32 s10, 15204352
    s_mov_b32 s11, 0x00020000
    s_mov_b32 s6, s4
    s_mov_b32 s7, s5
    s_add_u32 s6, s6, 36700160
    s_addc_u32 s7, s7, 0
    s_mov_b32 s52, s6
    s_and_b32 s53, s7, 0xffff
    s_mov_b32 s54, 131072
    s_mov_b32 s55, 0x00020000
    s_barrier
    s_add_u32 m0, s51, 0
    s_add_u32 s58, s41, 0
    buffer_load_dwordx4 v6, s[12:15], s58 offen offset:0 lds
    buffer_load_dwordx4 v7, s[12:15], s58 offen offset:1024 lds
    buffer_load_dwordx4 v8, s[12:15], s58 offen offset:2048 lds
    buffer_load_dwordx4 v9, s[12:15], s58 offen offset:3072 lds
    s_add_u32 m0, s51, 32768
    s_add_u32 s58, s41, 131072
    buffer_load_dwordx4 v6, s[12:15], s58 offen offset:0 lds
    buffer_load_dwordx4 v7, s[12:15], s58 offen offset:1024 lds
    buffer_load_dwordx4 v8, s[12:15], s58 offen offset:2048 lds
    buffer_load_dwordx4 v9, s[12:15], s58 offen offset:3072 lds
    s_add_u32 m0, s51, 65536
    s_add_u32 s58, s41, 262144
    buffer_load_dwordx4 v6, s[12:15], s58 offen offset:0 lds
    buffer_load_dwordx4 v7, s[12:15], s58 offen offset:1024 lds
    buffer_load_dwordx4 v8, s[12:15], s58 offen offset:2048 lds
    buffer_load_dwordx4 v9, s[12:15], s58 offen offset:3072 lds
    s_add_u32 m0, s51, 98304
    s_add_u32 s58, s41, 393216
    buffer_load_dwordx4 v6, s[12:15], s58 offen offset:0 lds
    buffer_load_dwordx4 v7, s[12:15], s58 offen offset:1024 lds
    buffer_load_dwordx4 v8, s[12:15], s58 offen offset:2048 lds
    buffer_load_dwordx4 v9, s[12:15], s58 offen offset:3072 lds
    s_barrier
    s_add_u32 m0, s50, 0
    s_add_u32 s58, s40, 0
    buffer_load_dwordx4 v2, s[8:11], s58 offen offset:0 lds
    buffer_load_dwordx4 v3, s[8:11], s58 offen offset:1024 lds
    buffer_load_dwordx4 v4, s[8:11], s58 offen offset:2048 lds
    buffer_load_dwordx4 v5, s[8:11], s58 offen offset:3072 lds
    s_add_u32 m0, s50, 32768
    s_add_u32 s58, s40, 128
    buffer_load_dwordx4 v2, s[8:11], s58 offen offset:0 lds
    buffer_load_dwordx4 v3, s[8:11], s58 offen offset:1024 lds
    buffer_load_dwordx4 v4, s[8:11], s58 offen offset:2048 lds
    buffer_load_dwordx4 v5, s[8:11], s58 offen offset:3072 lds
    s_add_u32 m0, s50, 65536
    s_add_u32 s58, s40, 256
    buffer_load_dwordx4 v2, s[8:11], s58 offen offset:0 lds
    buffer_load_dwordx4 v3, s[8:11], s58 offen offset:1024 lds
    buffer_load_dwordx4 v4, s[8:11], s58 offen offset:2048 lds
    buffer_load_dwordx4 v5, s[8:11], s58 offen offset:3072 lds
    s_add_u32 m0, s50, 98304
    s_add_u32 s58, s40, 384
    buffer_load_dwordx4 v2, s[8:11], s58 offen offset:0 lds
    buffer_load_dwordx4 v3, s[8:11], s58 offen offset:1024 lds
    buffer_load_dwordx4 v4, s[8:11], s58 offen offset:2048 lds
    buffer_load_dwordx4 v5, s[8:11], s58 offen offset:3072 lds
    s_add_u32 s40, s40, 512
    s_add_u32 s41, s41, 524288
    s_waitcnt vmcnt(12)
    s_barrier
    s_mov_b32 s16, s22
    s_and_b32 s17, s23, 0xffff
    s_mov_b32 s18, 4194304
    s_mov_b32 s19, 0x00020000
    s_mov_b32 s6, s4
    s_mov_b32 s7, s5
    s_add_u32 s6, s6, 16777216
    s_addc_u32 s7, s7, 0
    s_mov_b32 s24, s6
    s_and_b32 s25, s7, 0xffff
    s_mov_b32 s26, 2641920
    s_mov_b32 s27, 0x00020000
    s_mov_b32 s6, s4
    s_mov_b32 s7, s5
    s_add_u32 s6, s6, 20971520
    s_addc_u32 s7, s7, 0
    s_mov_b32 s36, s6
    s_and_b32 s37, s7, 0xffff
    s_mov_b32 s38, 16384
    s_mov_b32 s39, 0x00020000
    s_mov_b32 s63, 660480
    s_mov_b32 s64, 1320960
    s_mov_b32 s65, 1981440
    s_waitcnt vmcnt(8)
    s_barrier
    s_add_u32 m0, s43, s50
    s_nop 0
    buffer_load_dwordx4 v2, s[8:11], s40 offen offset:0 lds
    buffer_load_dwordx4 v3, s[8:11], s40 offen offset:1024 lds
    buffer_load_dwordx4 v4, s[8:11], s40 offen offset:2048 lds
    buffer_load_dwordx4 v5, s[8:11], s40 offen offset:3072 lds
    s_add_u32 m0, s43, s51
    s_nop 0
    buffer_load_dwordx4 v6, s[12:15], s41 offen offset:0 lds
    buffer_load_dwordx4 v7, s[12:15], s41 offen offset:1024 lds
    buffer_load_dwordx4 v8, s[12:15], s41 offen offset:2048 lds
    buffer_load_dwordx4 v9, s[12:15], s41 offen offset:3072 lds
    s_add_u32 s40, s40, 128
    s_add_u32 s41, s41, 131072
    s_add_u32 s43, s43, 32768
    s_cmp_ge_u32 s43, 131072
    s_cselect_b32 s43, 0, s43
    s_waitcnt vmcnt(12)
    s_barrier
    s_add_u32 m0, s43, s50
    s_nop 0
    buffer_load_dwordx4 v2, s[8:11], s40 offen offset:0 lds
    buffer_load_dwordx4 v3, s[8:11], s40 offen offset:1024 lds
    buffer_load_dwordx4 v4, s[8:11], s40 offen offset:2048 lds
    buffer_load_dwordx4 v5, s[8:11], s40 offen offset:3072 lds
    s_add_u32 m0, s43, s51
    s_nop 0
    buffer_load_dwordx4 v6, s[12:15], s41 offen offset:0 lds
    buffer_load_dwordx4 v7, s[12:15], s41 offen offset:1024 lds
    buffer_load_dwordx4 v8, s[12:15], s41 offen offset:2048 lds
    buffer_load_dwordx4 v9, s[12:15], s41 offen offset:3072 lds
    s_add_u32 s40, s40, 128
    s_add_u32 s41, s41, 131072
    s_add_u32 s43, s43, 32768
    s_cmp_ge_u32 s43, 131072
    s_cselect_b32 s43, 0, s43
    s_mov_b32 s44, 18
p2_ld_loop:
    s_waitcnt vmcnt(16)
    s_cmp_eq_u32 s44, 14
    s_cbranch_scc1 p2_ld_ypub
p2_ld_ypub_r:
    s_barrier
    s_add_u32 m0, s43, s50
    s_nop 0
    buffer_load_dwordx4 v2, s[8:11], s40 offen offset:0 lds
    buffer_load_dwordx4 v3, s[8:11], s40 offen offset:1024 lds
    buffer_load_dwordx4 v4, s[8:11], s40 offen offset:2048 lds
    buffer_load_dwordx4 v5, s[8:11], s40 offen offset:3072 lds
    s_add_u32 m0, s43, s51
    s_nop 0
    buffer_load_dwordx4 v6, s[12:15], s41 offen offset:0 lds
    buffer_load_dwordx4 v7, s[12:15], s41 offen offset:1024 lds
    buffer_load_dwordx4 v8, s[12:15], s41 offen offset:2048 lds
    buffer_load_dwordx4 v9, s[12:15], s41 offen offset:3072 lds
    s_add_u32 s40, s40, 128
    s_add_u32 s41, s41, 131072
    s_add_u32 s43, s43, 32768
    s_cmp_ge_u32 s43, 131072
    s_cselect_b32 s43, 0, s43
p2_ld_ypub_r2:
    s_sub_u32 s44, s44, 1
    s_cmp_lg_u32 s44, 13
    s_cbranch_scc1 p2_ld_loop
    s_lshr_b32 s58, s28, 1
    s_lshl_b32 s58, s58, 9
    s_and_b32 s59, s2, 3
    s_xor_b32 s59, s59, 1
    s_mul_i32 s59, s59, 112
    s_add_u32 s58, s58, s59
    v_lshlrev_b32 v30, 2, v1
    v_add_u32 v30, s58, v30
    v_mov_b32 v25, 0x7ffffff0
    s_cmp_eq_u32 s45, 3
    s_cselect_b32 s58, 28, 0
    v_cmp_gt_u32 vcc, s58, v1
    s_nop 1
    v_cndmask_b32 v30, v25, v30, vcc
    s_waitcnt vmcnt(16)
    s_barrier
    s_add_u32 m0, s43, s50
    s_nop 0
    buffer_load_dwordx4 v2, s[8:11], s40 offen offset:0 lds
    buffer_load_dwordx4 v3, s[8:11], s40 offen offset:1024 lds
    buffer_load_dwordx4 v4, s[8:11], s40 offen offset:2048 lds
    buffer_load_dwordx4 v5, s[8:11], s40 offen offset:3072 lds
    s_add_u32 m0, s43, s51
    s_nop 0
    buffer_load_dwordx4 v6, s[12:15], s41 offen offset:0 lds
    buffer_load_dwordx4 v7, s[12:15], s41 offen offset:1024 lds
    buffer_load_dwordx4 v8, s[12:15], s41 offen offset:2048 lds
    buffer_load_dwordx4 v9, s[12:15], s41 offen offset:3072 lds
    s_add_u32 s40, s40, 128
    s_add_u32 s41, s41, 131072
    s_add_u32 s43, s43, 32768
    s_cmp_ge_u32 s43, 131072
    s_cselect_b32 s43, 0, s43
    buffer_load_dword v31, v30, s[52:55], 0 offen sc1
    s_waitcnt vmcnt(17)
    s_barrier
    s_add_u32 m0, s43, s50
    s_nop 0
    buffer_load_dwordx4 v2, s[8:11], s40 offen offset:0 lds
    buffer_load_dwordx4 v3, s[8:11], s40 offen offset:1024 lds
    buffer_load_dwordx4 v4, s[8:11], s40 offen offset:2048 lds
    buffer_load_dwordx4 v5, s[8:11], s40 offen offset:3072 lds
    s_add_u32 m0, s43, s51
    s_nop 0
    buffer_load_dwordx4 v6, s[12:15], s41 offen offset:0 lds
    buffer_load_dwordx4 v7, s[12:15], s41 offen offset:1024 lds
    buffer_load_dwordx4 v8, s[12:15], s41 offen offset:2048 lds
    buffer_load_dwordx4 v9, s[12:15], s41 offen offset:3072 lds
    s_add_u32 s40, s40, 128
    s_add_u32 s41, s41, 131072
    s_add_u32 s43, s43, 32768
    s_cmp_ge_u32 s43, 131072
    s_cselect_b32 s43, 0, s43
    s_waitcnt vmcnt(17)
    s_barrier
    s_add_u32 m0, s43, s50
    s_nop 0
    buffer_load_dwordx4 v2, s[8:11], s40 offen offset:0 lds
    buffer_load_dwordx4 v3, s[8:11], s40 offen offset:1024 lds
    buffer_load_dwordx4 v4, s[8:11], s40 offen offset:2048 lds
    buffer_load_dwordx4 v5, s[8:11], s40 offen offset:3072 lds
    s_add_u32 m0, s43, s51
    s_nop 0
    buffer_load_dwordx4 v6, s[12:15], s41 offen offset:0 lds
    buffer_load_dwordx4 v7, s[12:15], s41 offen offset:1024 lds
    buffer_load_dwordx4 v8, s[12:15], s41 offen offset:2048 lds
    buffer_load_dwordx4 v9, s[12:15], s41 offen offset:3072 lds
    s_add_u32 s40, s40, 128
    s_add_u32 s41, s41, 131072
    s_add_u32 s43, s43, 32768
    s_cmp_ge_u32 s43, 131072
    s_cselect_b32 s43, 0, s43
    s_waitcnt vmcnt(16)
    s_cmp_eq_u32 s45, 3
    s_cbranch_scc0 rq_53
    s_mov_b32 s59, 0x8000
rl_54:
    v_cmp_ne_u32 vcc, s34, v31
    s_nop 4
    s_and_b32 s58, vcc_lo, 0xfffffff
    s_cbranch_scc0 rq_53
    s_sub_u32 s59, s59, 1
    s_cbranch_scc1 rq_53
    buffer_load_dword v31, v30, s[52:55], 0 offen sc1
    s_waitcnt vmcnt(0)
    s_branch rl_54
rq_53:
    s_barrier
    s_and_b32 s58, s2, 1
    s_mul_i32 s59, s58, 3584
    s_sub_u32 s40, s40, s59
    s_mul_i32 s59, s58, 3670016
    s_sub_u32 s41, s41, s59
    s_add_u32 m0, s43, s50
    s_nop 0
    buffer_load_dwordx4 v2, s[8:11], s40 offen offset:0 lds
    buffer_load_dwordx4 v3, s[8:11], s40 offen offset:1024 lds
    buffer_load_dwordx4 v4, s[8:11], s40 offen offset:2048 lds
    buffer_load_dwordx4 v5, s[8:11], s40 offen offset:3072 lds
    s_add_u32 m0, s43, s51
    s_nop 0
    buffer_load_dwordx4 v6, s[12:15], s41 offen offset:0 lds
    buffer_load_dwordx4 v7, s[12:15], s41 offen offset:1024 lds
    buffer_load_dwordx4 v8, s[12:15], s41 offen offset:2048 lds
    buffer_load_dwordx4 v9, s[12:15], s41 offen offset:3072 lds
    s_add_u32 s40, s40, 128
    s_add_u32 s41, s41, 131072
    s_add_u32 s43, s43, 32768
    s_cmp_ge_u32 s43, 131072
    s_cselect_b32 s43, 0, s43
    s_mov_b32 s44, 9
p2_ld_loopb:
    s_waitcnt vmcnt(16)
    s_barrier
    s_add_u32 m0, s43, s50
    s_nop 0
    buffer_load_dwordx4 v2, s[8:11], s40 offen offset:0 lds
    buffer_load_dwordx4 v3, s[8:11], s40 offen offset:1024 lds
    buffer_load_dwordx4 v4, s[8:11], s40 offen offset:2048 lds
    buffer_load_dwordx4 v5, s[8:11], s40 offen offset:3072 lds
    s_add_u32 m0, s43, s51
    s_nop 0
    buffer_load_dwordx4 v6, s[12:15], s41 offen offset:0 lds
    buffer_load_dwordx4 v7, s[12:15], s41 offen offset:1024 lds
    buffer_load_dwordx4 v8, s[12:15], s41 offen offset:2048 lds
    buffer_load_dwordx4 v9, s[12:15], s41 offen offset:3072 lds
    s_add_u32 s40, s40, 128
    s_add_u32 s41, s41, 131072
    s_add_u32 s43, s43, 32768
    s_cmp_ge_u32 s43, 131072
    s_cselect_b32 s43, 0, s43
    s_sub_u32 s44, s44, 1
    s_cmp_lg_u32 s44, 0
    s_cbranch_scc1 p2_ld_loopb
    s_and_b32 s58, s2, 7
    s_lshl_b32 s58, s58, 7
    s_add_u32 s58, s58, 65536
    v_lshlrev_b32 v30, 2, v1
    v_add_u32 v30, s58, v30
    v_mov_b32 v25, 0x7ffffff0
    s_cmp_eq_u32 s45, 3
    s_cselect_b32 s58, 32, 0
    v_cmp_gt_u32 vcc, s58, v1
    s_nop 1
    v_cndmask_b32 v30, v25, v30, vcc
    s_waitcnt vmcnt(16)
    s_barrier
    s_add_u32 m0, s43, s50
    s_nop 0
    buffer_load_dwordx4 v2, s[8:11], s40 offen offset:0 lds
    buffer_load_dwordx4 v3, s[8:11], s40 offen offset:1024 lds
    buffer_load_dwordx4 v4, s[8:11], s40 offen offset:2048 lds
    buffer_load_dwordx4 v5, s[8:11], s40 offen offset:3072 lds
    s_add_u32 m0, s43, s51
    s_nop 0
    buffer_load_dwordx4 v6, s[12:15], s41 offen offset:0 lds
    buffer_load_dwordx4 v7, s[12:15], s41 offen offset:1024 lds
    buffer_load_dwordx4 v8, s[12:15], s41 offen offset:2048 lds
    buffer_load_dwordx4 v9, s[12:15], s41 offen offset:3072 lds
    s_add_u32 s40, s40, 128
    s_add_u32 s41, s41, 131072
    s_add_u32 s43, s43, 32768
    s_cmp_ge_u32 s43, 131072
    s_cselect_b32 s43, 0, s43
    buffer_load_dword v31, v30, s[52:55], 0 offen sc1
    s_waitcnt vmcnt(17)
    s_barrier
    s_add_u32 m0, s43, s50
    s_nop 0
    buffer_load_dwordx4 v2, s[8:11], s40 offen offset:0 lds
    buffer_load_dwordx4 v3, s[8:11], s40 offen offset:1024 lds
    buffer_load_dwordx4 v4, s[8:11], s40 offen offset:2048 lds
    buffer_load_dwordx4 v5, s[8:11], s40 offen offset:3072 lds
    s_add_u32 m0, s43, s51
    s_nop 0
    buffer_load_dwordx4 v6, s[12:15], s41 offen offset:0 lds
    buffer_load_dwordx4 v7, s[12:15], s41 offen offset:1024 lds
    buffer_load_dwordx4 v8, s[12:15], s41 offen offset:2048 lds
    buffer_load_dwordx4 v9, s[12:15], s41 offen offset:3072 lds
    s_add_u32 s40, s40, 128
    s_add_u32 s41, s41, 131072
    s_add_u32 s43, s43, 32768
    s_cmp_ge_u32 s43, 131072
    s_cselect_b32 s43, 0, s43
    s_waitcnt vmcnt(17)
    s_barrier
    s_add_u32 m0, s43, s50
    s_nop 0
    buffer_load_dwordx4 v2, s[8:11], s40 offen offset:0 lds
    buffer_load_dwordx4 v3, s[8:11], s40 offen offset:1024 lds
    buffer_load_dwordx4 v4, s[8:11], s40 offen offset:2048 lds
    buffer_load_dwordx4 v5, s[8:11], s40 offen offset:3072 lds
    s_add_u32 m0, s43, s51
    s_nop 0
    buffer_load_dwordx4 v6, s[12:15], s41 offen offset:0 lds
    buffer_load_dwordx4 v7, s[12:15], s41 offen offset:1024 lds
    buffer_load_dwordx4 v8, s[12:15], s41 offen offset:2048 lds
    buffer_load_dwordx4 v9, s[12:15], s41 offen offset:3072 lds
    s_add_u32 s40, s40, 128
    s_add_u32 s41, s41, 131072
    s_add_u32 s43, s43, 32768
    s_cmp_ge_u32 s43, 131072
    s_cselect_b32 s43, 0, s43
    s_waitcnt vmcnt(16)
    s_cmp_eq_u32 s45, 3
    s_cbranch_scc0 yq_55
    s_mov_b32 s59, 0x8000
yl_56:
    v_cmp_ne_u32 vcc, s34, v31
    s_nop 4
    s_cmp_eq_u32 vcc_lo, 0
    s_cbranch_scc1 yq_55
    s_sub_u32 s59, s59, 1
    s_cbranch_scc1 yq_55
    buffer_load_dword v31, v30, s[52:55], 0 offen sc1
    s_waitcnt vmcnt(0)
    s_branch yl_56
yq_55:
    s_barrier
    s_add_u32 m0, s43, s50
    s_nop 0
    buffer_load_dwordx4 v2, s[8:11], s40 offen offset:0 lds
    buffer_load_dwordx4 v3, s[8:11], s40 offen offset:1024 lds
    buffer_load_dwordx4 v4, s[8:11], s40 offen offset:2048 lds
    buffer_load_dwordx4 v5, s[8:11], s40 offen offset:3072 lds
    s_add_u32 m0, s43, s51
    s_nop 0
    buffer_load_dwordx4 v6, s[12:15], s41 offen offset:0 lds
    buffer_load_dwordx4 v7, s[12:15], s41 offen offset:1024 lds
    buffer_load_dwordx4 v8, s[12:15], s41 offen offset:2048 lds
    buffer_load_dwordx4 v9, s[12:15], s41 offen offset:3072 lds
    s_add_u32 s40, s40, 128
    s_add_u32 s41, s41, 131072
    s_add_u32 s43, s43, 32768
    s_cmp_ge_u32 s43, 131072
    s_cselect_b32 s43, 0, s43
    v_lshrrev_b32 v40, 3, v1
    v_and_b32 v41, 7, v1
    v_add_u32 v42, s30, v40
    s_lshr_b32 s46, s31, 1
    s_cmp_ge_u32 s46, 512
    s_cselect_b32 s62, 1, 0
    s_cbranch_scc1 p2_ymir
    v_lshl_add_u32 v43, v41, 3, s46
    s_branch p2_ygo
p2_ymir:
    s_sub_u32 s46, 1016, s46
    v_lshlrev_b32 v43, 3, v41
    v_sub_u32 v43, s46, v43
p2_ygo:
    s_lshl_b32 s60, s29, 7
    s_sub_u32 s61, 896, s60
    s_cmp_eq_u32 s62, 1
    s_cselect_b32 s60, s61, s60
    s_lshr_b32 s58, s45, 1
    s_lshl_b32 s59, s58, 4
    v_lshrrev_b32 v44, 3, v1
    v_add_u32 v44, s30, v44
    v_add_u32 v44, s59, v44
    v_add_u32 v44, 0, v44
    v_sub_u32 v45, 2048, v44
    v_min_u32 v45, v44, v45
    v_mul_u32_u24 v45, 640, v45
    v_and_b32 v44, 7, v1
    v_lshl_add_u32 v20, v44, 4, v45
    v_add_u32 v20, s60, v20
    v_lshrrev_b32 v44, 3, v1
    v_add_u32 v44, s30, v44
    v_add_u32 v44, s59, v44
    v_add_u32 v44, 8, v44
    v_sub_u32 v45, 2048, v44
    v_min_u32 v45, v44, v45
    v_mul_u32_u24 v45, 640, v45
    v_and_b32 v44, 7, v1
    v_lshl_add_u32 v21, v44, 4, v45
    v_add_u32 v21, s60, v21
    s_and_b32 s61, s45, 1
    s_lshl_b32 s61, s61, 12
    s_lshl_b32 s59, s59, 7
    s_add_u32 s61, s61, s59
    s_add_u32 s61, s61, 16384
    s_lshl_b32 s59, s28, 7
    s_lshl_b32 s58, s67, 5
    s_add_u32 s59, s59, s58
    v_lshrrev_b32 v44, 5, v1
    v_lshlrev_b32 v44, 6, v44
    v_and_b32 v45, 31, v1
    v_add_u32 v44, v44, v45
    v_add_u32 v44, s59, v44
    v_sub_u32 v45, 2048, v44
    v_min_u32 v45, v44, v45
    v_mul_u32_u24 v22, 640, v45
    v_add_u32 v22, s60, v22
    v_add_u32 v22, 128, v22
    s_waitcnt vmcnt(16)
    s_barrier
    s_add_u32 m0, s61, 0
    s_nop 0
    buffer_load_dwordx4 v20, s[24:27], 0 offen lds
    s_add_u32 m0, s61, 1024
    s_nop 0
    buffer_load_dwordx4 v21, s[24:27], 0 offen lds
    s_add_u32 m0, s61, 8192
    s_nop 0
    buffer_load_dwordx4 v20, s[24:27], s63 offen lds
    s_add_u32 m0, s61, 9216
    s_nop 0
    buffer_load_dwordx4 v21, s[24:27], s63 offen lds
    s_waitcnt vmcnt(12)
    s_barrier
    s_add_u32 m0, s61, 16384
    s_nop 0
    buffer_load_dwordx4 v20, s[24:27], s64 offen lds
    s_add_u32 m0, s61, 17408
    s_nop 0
    buffer_load_dwordx4 v21, s[24:27], s64 offen lds
    s_add_u32 m0, s61, 24576
    s_nop 0
    buffer_load_dwordx4 v20, s[24:27], s65 offen lds
    s_add_u32 m0, s61, 25600
    s_nop 0
    buffer_load_dwordx4 v21, s[24:27], s65 offen lds
    s_cmp_eq_u32 s62, 1
    s_cbranch_scc0 yx_57
    s_cmp_lt_u32 s45, 2
    s_cbranch_scc0 yx_57
    s_lshl_b32 s58, s45, 10
    s_add_u32 m0, s58, 49152
    s_mul_i32 s58, s45, 1320960
    buffer_load_dwordx4 v22, s[24:27], s58 offen lds
    s_branch yxe_58
yx_57:
    v_mov_b32 v23, 0x7ffffff0
    buffer_load_dword v24, v23, s[24:27], 0 offen
yxe_58:
    s_waitcnt vmcnt(9)
    s_barrier
    v_add_u32 v44, 0, v42
    v_lshlrev_b32 v44, 3, v44
    buffer_load_dwordx2 v[32:33], v44, s[36:39], 0 offen
    v_add_u32 v44, 8, v42
    v_lshlrev_b32 v44, 3, v44
    buffer_load_dwordx2 v[34:35], v44, s[36:39], 0 offen
    v_add_u32 v44, 16, v42
    v_lshlrev_b32 v44, 3, v44
    buffer_load_dwordx2 v[36:37], v44, s[36:39], 0 offen
    v_add_u32 v44, 24, v42
    v_lshlrev_b32 v44, 3, v44
    buffer_load_dwordx2 v[38:39], v44, s[36:39], 0 offen
    s_mov_b32 s92, s20
    s_and_b32 s93, s21, 0xffff
    s_mov_b32 s94, 2048
    s_mov_b32 s95, 0x00020000
    v_and_b32 v44, 7, v1
    v_lshlrev_b32 v44, 4, v44
    buffer_load_dwordx4 v[188:191], v44, s[92:95], s31 offen
    s_waitcnt vmcnt(5)
    s_barrier
    s_cmp_eq_u32 s30, 1024
    s_cbranch_scc0 r4_59
    v_cmp_gt_u32 vcc, 8, v1
    v_mov_b32 v45, 0x7ff00000
    s_nop 0
    v_cndmask_b32 v44, v45, v43, vcc
    s_mov_b32 s58, 656000
    s_add_u32 s59, s58, s63
    buffer_load_dwordx3 v[164:166], v44, s[24:27], s58 offen
    buffer_load_dwordx2 v[168:169], v44, s[24:27], s59 offen
    s_mov_b32 s58, 656640
    s_add_u32 s59, s58, s63
    buffer_load_dwordx3 v[172:174], v44, s[24:27], s58 offen
    buffer_load_dwordx2 v[176:177], v44, s[24:27], s59 offen
    s_mov_b32 s58, 657280
    s_add_u32 s59, s58, s63
    buffer_load_dwordx3 v[180:182], v44, s[24:27], s58 offen
    buffer_load_dwordx2 v[184:185], v44, s[24:27], s59 offen
r4_59:
    s_and_b32 s61, s45, 1
    s_lshl_b32 s58, s61, 12
    s_add_u32 s58, s58, 16384
    v_lshrrev_b32 v44, 3, v1
    v_lshlrev_b32 v45, 7, v44
    v_add_u32 v45, s58, v45
    v_subrev_u32 v46, s60, v43
    v_add_u32 v20, v45, v46
    s_lshl_b32 s58, s61, 9
    s_add_u32 s58, s58, 49152
    v_lshlrev_b32 v47, 4, v44
    v_add_u32 v47, s58, v47
    v_cmp_eq_u32 vcc, 120, v46
    v_add_u32 v21, 8, v20
    s_cmp_eq_u32 s62, 1
    s_cbranch_scc0 yf_60
    v_add_u32 v48, 0, v21
    v_add_u32 v49, 0, v47
    v_cndmask_b32 v22, v48, v49, vcc
    v_add_u32 v48, 16384, v21
    v_add_u32 v49, 1024, v47
    v_cndmask_b32 v23, v48, v49, vcc
    ds_read_b64 v[64:65], v20 offset:0
    ds_read_b32 v66, v22
    ds_read_b64 v[68:69], v20 offset:8192
    ds_read_b64 v[72:73], v20 offset:16384
    ds_read_b32 v74, v23
    ds_read_b64 v[76:77], v20 offset:24576
    v_add_u32 v48, 1024, v21
    v_add_u32 v49, 128, v47
    v_cndmask_b32 v22, v48, v49, vcc
    v_add_u32 v48, 17408, v21
    v_add_u32 v49, 1152, v47
    v_cndmask_b32 v23, v48, v49, vcc
    ds_read_b64 v[80:81], v20 offset:1024
    ds_read_b32 v82, v22
    ds_read_b64 v[84:85], v20 offset:9216
    ds_read_b64 v[88:89], v20 offset:17408
    ds_read_b32 v90, v23
    ds_read_b64 v[92:93], v20 offset:25600
    s_waitcnt lgkmcnt(0)
    v_add_u32 v48, 2048, v21
    v_add_u32 v49, 256, v47
    v_cndmask_b32 v22, v48, v49, vcc
    v_add_u32 v48, 18432, v21
    v_add_u32 v49, 1280, v47
    v_cndmask_b32 v23, v48, v49, vcc
    ds_read_b64 v[96:97], v20 offset:2048
    ds_read_b32 v98, v22
    ds_read_b64 v[100:101], v20 offset:10240
    ds_read_b64 v[104:105], v20 offset:18432
    ds_read_b32 v106, v23
    ds_read_b64 v[108:109], v20 offset:26624
    v_add_u32 v48, 3072, v21
    v_add_u32 v49, 384, v47
    v_cndmask_b32 v22, v48, v49, vcc
    v_add_u32 v48, 19456, v21
    v_add_u32 v49, 1408, v47
    v_cndmask_b32 v23, v48, v49, vcc
    ds_read_b64 v[112:113], v20 offset:3072
    ds_read_b32 v114, v22
    ds_read_b64 v[116:117], v20 offset:11264
    ds_read_b64 v[120:121], v20 offset:19456
    ds_read_b32 v122, v23
    ds_read_b64 v[124:125], v20 offset:27648
    s_waitcnt lgkmcnt(0)
    s_branch yd_61
yf_60:
    ds_read_b64 v[64:65], v20 offset:0
    ds_read_b64 v[68:69], v20 offset:8192
    ds_read_b64 v[72:73], v20 offset:16384
    ds_read_b64 v[76:77], v20 offset:24576
    ds_read_b64 v[80:81], v20 offset:1024
    ds_read_b64 v[84:85], v20 offset:9216
    ds_read_b64 v[88:89], v20 offset:17408
    ds_read_b64 v[92:93], v20 offset:25600
    s_waitcnt lgkmcnt(0)
    ds_read_b64 v[96:97], v20 offset:2048
    ds_read_b64 v[100:101], v20 offset:10240
    ds_read_b64 v[104:105], v20 offset:18432
    ds_read_b64 v[108:109], v20 offset:26624
    ds_read_b64 v[112:113], v20 offset:3072
    ds_read_b64 v[116:117], v20 offset:11264
    ds_read_b64 v[120:121], v20 offset:19456
    ds_read_b64 v[124:125], v20 offset:27648
    s_waitcnt lgkmcnt(0)
yd_61:
    s_waitcnt vmcnt(0)
    s_cmp_eq_u32 s30, 1024
    s_cbranch_scc0 r5_62
    v_lshlrev_b32 v46, 16, v64
    v_and_b32 v47, 0xffff0000, v64
    v_lshlrev_b32 v48, 16, v164
    v_and_b32 v49, 0xffff0000, v164
    v_pk_add_f32 v[46:47], v[46:47], v[48:49]
    v_lshlrev_b32 v48, 16, v172
    v_and_b32 v49, 0xffff0000, v172
    v_pk_add_f32 v[46:47], v[46:47], v[48:49]
    v_lshlrev_b32 v48, 16, v180
    v_and_b32 v49, 0xffff0000, v180
    v_pk_add_f32 v[46:47], v[46:47], v[48:49]
    v_cvt_pk_bf16_f32 v64, v46, v47
    v_lshlrev_b32 v46, 16, v65
    v_and_b32 v47, 0xffff0000, v65
    v_lshlrev_b32 v48, 16, v165
    v_and_b32 v49, 0xffff0000, v165
    v_pk_add_f32 v[46:47], v[46:47], v[48:49]
    v_lshlrev_b32 v48, 16, v173
    v_and_b32 v49, 0xffff0000, v173
    v_pk_add_f32 v[46:47], v[46:47], v[48:49]
    v_lshlrev_b32 v48, 16, v181
    v_and_b32 v49, 0xffff0000, v181
    v_pk_add_f32 v[46:47], v[46:47], v[48:49]
    v_cvt_pk_bf16_f32 v65, v46, v47
    v_lshlrev_b32 v46, 16, v66
    v_and_b32 v47, 0xffff0000, v66
    v_lshlrev_b32 v48, 16, v166
    v_and_b32 v49, 0xffff0000, v166
    v_pk_add_f32 v[46:47], v[46:47], v[48:49]
    v_lshlrev_b32 v48, 16, v174
    v_and_b32 v49, 0xffff0000, v174
    v_pk_add_f32 v[46:47], v[46:47], v[48:49]
    v_lshlrev_b32 v48, 16, v182
    v_and_b32 v49, 0xffff0000, v182
    v_pk_add_f32 v[46:47], v[46:47], v[48:49]
    v_cvt_pk_bf16_f32 v66, v46, v47
    v_lshlrev_b32 v46, 16, v68
    v_and_b32 v47, 0xffff0000, v68
    v_lshlrev_b32 v48, 16, v168
    v_and_b32 v49, 0xffff0000, v168
    v_pk_add_f32 v[46:47], v[46:47], v[48:49]
    v_lshlrev_b32 v48, 16, v176
    v_and_b32 v49, 0xffff0000, v176
    v_pk_add_f32 v[46:47], v[46:47], v[48:49]
    v_lshlrev_b32 v48, 16, v184
    v_and_b32 v49, 0xffff0000, v184
    v_pk_add_f32 v[46:47], v[46:47], v[48:49]
    v_cvt_pk_bf16_f32 v68, v46, v47
    v_lshlrev_b32 v46, 16, v69
    v_and_b32 v47, 0xffff0000, v69
    v_lshlrev_b32 v48, 16, v169
    v_and_b32 v49, 0xffff0000, v169
    v_pk_add_f32 v[46:47], v[46:47], v[48:49]
    v_lshlrev_b32 v48, 16, v177
    v_and_b32 v49, 0xffff0000, v177
    v_pk_add_f32 v[46:47], v[46:47], v[48:49]
    v_lshlrev_b32 v48, 16, v185
    v_and_b32 v49, 0xffff0000, v185
    v_pk_add_f32 v[46:47], v[46:47], v[48:49]
    v_cvt_pk_bf16_f32 v69, v46, v47
r5_62:
    v_add_u32 v44, 0, v42
    v_cmp_lt_u32 vcc, 1024, v44
    s_nop 1
    v_cndmask_b32 v45, 0, 1, vcc
    v_xor_b32 v45, s62, v45
    v_cmp_eq_u32 vcc, 1, v45
    v_sub_f32 v46, 0, v32
    s_nop 0
    v_cndmask_b32 v46, v46, v32, vcc
    v_mov_b32 v47, v46
    v_mov_b32 v48, v32
    v_mov_b32 v49, v32
    s_cmp_eq_u32 s62, 1
    s_cbranch_scc1 fm_63
    v_lshlrev_b32 v50, 16, v64
    v_lshlrev_b32 v51, 16, v68
    v_lshlrev_b32 v52, 16, v72
    v_lshlrev_b32 v53, 16, v76
    v_pk_mul_f32 v[128:129], v[50:51], v[48:49]
    v_pk_fma_f32 v[128:129], v[52:53], v[46:47], v[128:129]
    v_and_b32 v50, 0xffff0000, v64
    v_and_b32 v51, 0xffff0000, v68
    v_and_b32 v52, 0xffff0000, v72
    v_and_b32 v53, 0xffff0000, v76
    v_pk_mul_f32 v[130:131], v[50:51], v[48:49]
    v_pk_fma_f32 v[130:131], v[52:53], v[46:47], v[130:131]
    v_lshlrev_b32 v50, 16, v65
    v_lshlrev_b32 v51, 16, v69
    v_lshlrev_b32 v52, 16, v73
    v_lshlrev_b32 v53, 16, v77
    v_pk_mul_f32 v[132:133], v[50:51], v[48:49]
    v_pk_fma_f32 v[132:133], v[52:53], v[46:47], v[132:133]
    v_and_b32 v50, 0xffff0000, v65
    v_and_b32 v51, 0xffff0000, v69
    v_and_b32 v52, 0xffff0000, v73
    v_and_b32 v53, 0xffff0000, v77
    v_pk_mul_f32 v[134:135], v[50:51], v[48:49]
    v_pk_fma_f32 v[134:135], v[52:53], v[46:47], v[134:135]
    s_branch fe_64
fm_63:
    v_lshlrev_b32 v50, 16, v66
    v_and_b32 v51, 0xffff0000, v69
    v_lshlrev_b32 v52, 16, v74
    v_and_b32 v53, 0xffff0000, v77
    v_pk_mul_f32 v[128:129], v[50:51], v[48:49]
    v_pk_fma_f32 v[128:129], v[52:53], v[46:47], v[128:129]
    v_and_b32 v50, 0xffff0000, v65
    v_lshlrev_b32 v51, 16, v69
    v_and_b32 v52, 0xffff0000, v73
    v_lshlrev_b32 v53, 16, v77
    v_pk_mul_f32 v[130:131], v[50:51], v[48:49]
    v_pk_fma_f32 v[130:131], v[52:53], v[46:47], v[130:131]
    v_lshlrev_b32 v50, 16, v65
    v_and_b32 v51, 0xffff0000, v68
    v_lshlrev_b32 v52, 16, v73
    v_and_b32 v53, 0xffff0000, v76
    v_pk_mul_f32 v[132:133], v[50:51], v[48:49]
    v_pk_fma_f32 v[132:133], v[52:53], v[46:47], v[132:133]
    v_and_b32 v50, 0xffff0000, v64
    v_lshlrev_b32 v51, 16, v68
    v_and_b32 v52, 0xffff0000, v72
    v_lshlrev_b32 v53, 16, v76
    v_pk_mul_f32 v[134:135], v[50:51], v[48:49]
    v_pk_fma_f32 v[134:135], v[52:53], v[46:47], v[134:135]
fe_64:
    v_add_u32 v44, 8, v42
    v_cmp_lt_u32 vcc, 1024, v44
    s_nop 1
    v_cndmask_b32 v45, 0, 1, vcc
    v_xor_b32 v45, s62, v45
    v_cmp_eq_u32 vcc, 1, v45
    v_sub_f32 v46, 0, v34
    s_nop 0
    v_cndmask_b32 v46, v46, v34, vcc
    v_mov_b32 v47, v46
    v_mov_b32 v48, v34
    v_mov_b32 v49, v34
    s_cmp_eq_u32 s62, 1
    s_cbranch_scc1 fm_65
    v_lshlrev_b32 v50, 16, v80
    v_lshlrev_b32 v51, 16, v84
    v_lshlrev_b32 v52, 16, v88
    v_lshlrev_b32 v53, 16, v92
    v_pk_mul_f32 v[136:137], v[50:51], v[48:49]
    v_pk_fma_f32 v[136:137], v[52:53], v[46:47], v[136:137]
    v_and_b32 v50, 0xffff0000, v80
    v_and_b32 v51, 0xffff0000, v84
    v_and_b32 v52, 0xffff0000, v88
    v_and_b32 v53, 0xffff0000, v92
    v_pk_mul_f32 v[138:139], v[50:51], v[48:49]
    v_pk_fma_f32 v[138:139], v[52:53], v[46:47], v[138:139]
    v_lshlrev_b32 v50, 16, v81
    v_lshlrev_b32 v51, 16, v85
    v_lshlrev_b32 v52, 16, v89
    v_lshlrev_b32 v53, 16, v93
    v_pk_mul_f32 v[140:141], v[50:51], v[48:49]
    v_pk_fma_f32 v[140:141], v[52:53], v[46:47], v[140:141]
    v_and_b32 v50, 0xffff0000, v81
    v_and_b32 v51, 0xffff0000, v85
    v_and_b32 v52, 0xffff0000, v89
    v_and_b32 v53, 0xffff0000, v93
    v_pk_mul_f32 v[142:143], v[50:51], v[48:49]
    v_pk_fma_f32 v[142:143], v[52:53], v[46:47], v[142:143]
    s_branch fe_66
fm_65:
    v_lshlrev_b32 v50, 16, v82
    v_and_b32 v51, 0xffff0000, v85
    v_lshlrev_b32 v52, 16, v90
    v_and_b32 v53, 0xffff0000, v93
    v_pk_mul_f32 v[136:137], v[50:51], v[48:49]
    v_pk_fma_f32 v[136:137], v[52:53], v[46:47], v[136:137]
    v_and_b32 v50, 0xffff0000, v81
    v_lshlrev_b32 v51, 16, v85
    v_and_b32 v52, 0xffff0000, v89
    v_lshlrev_b32 v53, 16, v93
    v_pk_mul_f32 v[138:139], v[50:51], v[48:49]
    v_pk_fma_f32 v[138:139], v[52:53], v[46:47], v[138:139]
    v_lshlrev_b32 v50, 16, v81
    v_and_b32 v51, 0xffff0000, v84
    v_lshlrev_b32 v52, 16, v89
    v_and_b32 v53, 0xffff0000, v92
    v_pk_mul_f32 v[140:141], v[50:51], v[48:49]
    v_pk_fma_f32 v[140:141], v[52:53], v[46:47], v[140:141]
    v_and_b32 v50, 0xffff0000, v80
    v_lshlrev_b32 v51, 16, v84
    v_and_b32 v52, 0xffff0000, v88
    v_lshlrev_b32 v53, 16, v92
    v_pk_mul_f32 v[142:143], v[50:51], v[48:49]
    v_pk_fma_f32 v[142:143], v[52:53], v[46:47], v[142:143]
fe_66:
    v_add_u32 v44, 16, v42
    v_cmp_lt_u32 vcc, 1024, v44
    s_nop 1
    v_cndmask_b32 v45, 0, 1, vcc
    v_xor_b32 v45, s62, v45
    v_cmp_eq_u32 vcc, 1, v45
    v_sub_f32 v46, 0, v36
    s_nop 0
    v_cndmask_b32 v46, v46, v36, vcc
    v_mov_b32 v47, v46
    v_mov_b32 v48, v36
    v_mov_b32 v49, v36
    s_cmp_eq_u32 s62, 1
    s_cbranch_scc1 fm_67
    v_lshlrev_b32 v50, 16, v96
    v_lshlrev_b32 v51, 16, v100
    v_lshlrev_b32 v52, 16, v104
    v_lshlrev_b32 v53, 16, v108
    v_pk_mul_f32 v[144:145], v[50:51], v[48:49]
    v_pk_fma_f32 v[144:145], v[52:53], v[46:47], v[144:145]
    v_and_b32 v50, 0xffff0000, v96
    v_and_b32 v51, 0xffff0000, v100
    v_and_b32 v52, 0xffff0000, v104
    v_and_b32 v53, 0xffff0000, v108
    v_pk_mul_f32 v[146:147], v[50:51], v[48:49]
    v_pk_fma_f32 v[146:147], v[52:53], v[46:47], v[146:147]
    v_lshlrev_b32 v50, 16, v97
    v_lshlrev_b32 v51, 16, v101
    v_lshlrev_b32 v52, 16, v105
    v_lshlrev_b32 v53, 16, v109
    v_pk_mul_f32 v[148:149], v[50:51], v[48:49]
    v_pk_fma_f32 v[148:149], v[52:53], v[46:47], v[148:149]
    v_and_b32 v50, 0xffff0000, v97
    v_and_b32 v51, 0xffff0000, v101
    v_and_b32 v52, 0xffff0000, v105
    v_and_b32 v53, 0xffff0000, v109
    v_pk_mul_f32 v[150:151], v[50:51], v[48:49]
    v_pk_fma_f32 v[150:151], v[52:53], v[46:47], v[150:151]
    s_branch fe_68
fm_67:
    v_lshlrev_b32 v50, 16, v98
    v_and_b32 v51, 0xffff0000, v101
    v_lshlrev_b32 v52, 16, v106
    v_and_b32 v53, 0xffff0000, v109
    v_pk_mul_f32 v[144:145], v[50:51], v[48:49]
    v_pk_fma_f32 v[144:145], v[52:53], v[46:47], v[144:145]
    v_and_b32 v50, 0xffff0000, v97
    v_lshlrev_b32 v51, 16, v101
    v_and_b32 v52, 0xffff0000, v105
    v_lshlrev_b32 v53, 16, v109
    v_pk_mul_f32 v[146:147], v[50:51], v[48:49]
    v_pk_fma_f32 v[146:147], v[52:53], v[46:47], v[146:147]
    v_lshlrev_b32 v50, 16, v97
    v_and_b32 v51, 0xffff0000, v100
    v_lshlrev_b32 v52, 16, v105
    v_and_b32 v53, 0xffff0000, v108
    v_pk_mul_f32 v[148:149], v[50:51], v[48:49]
    v_pk_fma_f32 v[148:149], v[52:53], v[46:47], v[148:149]
    v_and_b32 v50, 0xffff0000, v96
    v_lshlrev_b32 v51, 16, v100
    v_and_b32 v52, 0xffff0000, v104
    v_lshlrev_b32 v53, 16, v108
    v_pk_mul_f32 v[150:151], v[50:51], v[48:49]
    v_pk_fma_f32 v[150:151], v[52:53], v[46:47], v[150:151]
fe_68:
    v_add_u32 v44, 24, v42
    v_cmp_lt_u32 vcc, 1024, v44
    s_nop 1
    v_cndmask_b32 v45, 0, 1, vcc
    v_xor_b32 v45, s62, v45
    v_cmp_eq_u32 vcc, 1, v45
    v_sub_f32 v46, 0, v38
    s_nop 0
    v_cndmask_b32 v46, v46, v38, vcc
    v_mov_b32 v47, v46
    v_mov_b32 v48, v38
    v_mov_b32 v49, v38
    s_cmp_eq_u32 s62, 1
    s_cbranch_scc1 fm_69
    v_lshlrev_b32 v50, 16, v112
    v_lshlrev_b32 v51, 16, v116
    v_lshlrev_b32 v52, 16, v120
    v_lshlrev_b32 v53, 16, v124
    v_pk_mul_f32 v[152:153], v[50:51], v[48:49]
    v_pk_fma_f32 v[152:153], v[52:53], v[46:47], v[152:153]
    v_and_b32 v50, 0xffff0000, v112
    v_and_b32 v51, 0xffff0000, v116
    v_and_b32 v52, 0xffff0000, v120
    v_and_b32 v53, 0xffff0000, v124
    v_pk_mul_f32 v[154:155], v[50:51], v[48:49]
    v_pk_fma_f32 v[154:155], v[52:53], v[46:47], v[154:155]
    v_lshlrev_b32 v50, 16, v113
    v_lshlrev_b32 v51, 16, v117
    v_lshlrev_b32 v52, 16, v121
    v_lshlrev_b32 v53, 16, v125
    v_pk_mul_f32 v[156:157], v[50:51], v[48:49]
    v_pk_fma_f32 v[156:157], v[52:53], v[46:47], v[156:157]
    v_and_b32 v50, 0xffff0000, v113
    v_and_b32 v51, 0xffff0000, v117
    v_and_b32 v52, 0xffff0000, v121
    v_and_b32 v53, 0xffff0000, v125
    v_pk_mul_f32 v[158:159], v[50:51], v[48:49]
    v_pk_fma_f32 v[158:159], v[52:53], v[46:47], v[158:159]
    s_branch fe_70
fm_69:
    v_lshlrev_b32 v50, 16, v114
    v_and_b32 v51, 0xffff0000, v117
    v_lshlrev_b32 v52, 16, v122
    v_and_b32 v53, 0xffff0000, v125
    v_pk_mul_f32 v[152:153], v[50:51], v[48:49]
    v_pk_fma_f32 v[152:153], v[52:53], v[46:47], v[152:153]
    v_and_b32 v50, 0xffff0000, v113
    v_lshlrev_b32 v51, 16, v117
    v_and_b32 v52, 0xffff0000, v121
    v_lshlrev_b32 v53, 16, v125
    v_pk_mul_f32 v[154:155], v[50:51], v[48:49]
    v_pk_fma_f32 v[154:155], v[52:53], v[46:47], v[154:155]
    v_lshlrev_b32 v50, 16, v113
    v_and_b32 v51, 0xffff0000, v116
    v_lshlrev_b32 v52, 16, v121
    v_and_b32 v53, 0xffff0000, v124
    v_pk_mul_f32 v[156:157], v[50:51], v[48:49]
    v_pk_fma_f32 v[156:157], v[52:53], v[46:47], v[156:157]
    v_and_b32 v50, 0xffff0000, v112
    v_lshlrev_b32 v51, 16, v116
    v_and_b32 v52, 0xffff0000, v120
    v_lshlrev_b32 v53, 16, v124
    v_pk_mul_f32 v[158:159], v[50:51], v[48:49]
    v_pk_fma_f32 v[158:159], v[52:53], v[46:47], v[158:159]
fe_70:
    v_lshlrev_b32 v192, 16, v188
    v_and_b32 v193, 0xffff0000, v188
    v_lshlrev_b32 v194, 16, v189
    v_and_b32 v195, 0xffff0000, v189
    v_lshlrev_b32 v196, 16, v190
    v_and_b32 v197, 0xffff0000, v190
    v_lshlrev_b32 v198, 16, v191
    v_and_b32 v199, 0xffff0000, v191
    v_mov_b32 v46, v33
    v_mov_b32 v47, v33
    v_pk_fma_f32 v[128:129], v[192:193], v[46:47], v[128:129]
    v_pk_fma_f32 v[130:131], v[194:195], v[46:47], v[130:131]
    v_pk_fma_f32 v[132:133], v[196:197], v[46:47], v[132:133]
    v_pk_fma_f32 v[134:135], v[198:199], v[46:47], v[134:135]
    v_mov_b32 v46, v35
    v_mov_b32 v47, v35
    v_pk_fma_f32 v[136:137], v[192:193], v[46:47], v[136:137]
    v_pk_fma_f32 v[138:139], v[194:195], v[46:47], v[138:139]
    v_pk_fma_f32 v[140:141], v[196:197], v[46:47], v[140:141]
    v_pk_fma_f32 v[142:143], v[198:199], v[46:47], v[142:143]
    v_mov_b32 v46, v37
    v_mov_b32 v47, v37
    v_pk_fma_f32 v[144:145], v[192:193], v[46:47], v[144:145]
    v_pk_fma_f32 v[146:147], v[194:195], v[46:47], v[146:147]
    v_pk_fma_f32 v[148:149], v[196:197], v[46:47], v[148:149]
    v_pk_fma_f32 v[150:151], v[198:199], v[46:47], v[150:151]
    v_mov_b32 v46, v39
    v_mov_b32 v47, v39
    v_pk_fma_f32 v[152:153], v[192:193], v[46:47], v[152:153]
    v_pk_fma_f32 v[154:155], v[194:195], v[46:47], v[154:155]
    v_pk_fma_f32 v[156:157], v[196:197], v[46:47], v[156:157]
    v_pk_fma_f32 v[158:159], v[198:199], v[46:47], v[158:159]
    s_lshl_b32 s66, s45, 12
    v_lshrrev_b32 v50, 3, v1
    v_and_b32 v52, 7, v1
    v_xor_b32 v52, v52, v50
    v_lshlrev_b32 v53, 7, v50
    v_lshl_add_u32 v53, v52, 4, v53
    v_add_u32 v62, s66, v53
    v_add_u32 v50, s30, v50
    v_lshlrev_b32 v50, 11, v50
    v_and_b32 v52, 7, v1
    v_lshl_add_u32 v50, v52, 4, v50
    v_add_u32 v63, s31, v50
    s_barrier
    s_barrier
    s_barrier
    ds_read_b128 v[64:67], v62 offset:0
    ds_read_b128 v[68:71], v62 offset:1024
    ds_read_b128 v[72:75], v62 offset:2048
    ds_read_b128 v[76:79], v62 offset:3072
    s_waitcnt lgkmcnt(3)
    v_mov_b32 v46, v33
    v_mov_b32 v47, v33
    v_lshlrev_b32 v48, 16, v64
    v_and_b32 v49, 0xffff0000, v64
    v_pk_fma_f32 v[128:129], v[48:49], v[46:47], v[128:129]
    v_cvt_pk_bf16_f32 v64, v128, v129
    v_lshlrev_b32 v48, 16, v65
    v_and_b32 v49, 0xffff0000, v65
    v_pk_fma_f32 v[130:131], v[48:49], v[46:47], v[130:131]
    v_cvt_pk_bf16_f32 v65, v130, v131
    v_lshlrev_b32 v48, 16, v66
    v_and_b32 v49, 0xffff0000, v66
    v_pk_fma_f32 v[132:133], v[48:49], v[46:47], v[132:133]
    v_cvt_pk_bf16_f32 v66, v132, v133
    v_lshlrev_b32 v48, 16, v67
    v_and_b32 v49, 0xffff0000, v67
    v_pk_fma_f32 v[134:135], v[48:49], v[46:47], v[134:135]
    v_cvt_pk_bf16_f32 v67, v134, v135
    s_mov_b32 s47, 0
    buffer_store_dwordx4 v[64:67], v63, s[16:19], s47 offen sc0 sc1
    s_waitcnt lgkmcnt(2)
    v_mov_b32 v46, v35
    v_mov_b32 v47, v35
    v_lshlrev_b32 v48, 16, v68
    v_and_b32 v49, 0xffff0000, v68
    v_pk_fma_f32 v[136:137], v[48:49], v[46:47], v[136:137]
    v_cvt_pk_bf16_f32 v68, v136, v137
    v_lshlrev_b32 v48, 16, v69
    v_and_b32 v49, 0xffff0000, v69
    v_pk_fma_f32 v[138:139], v[48:49], v[46:47], v[138:139]
    v_cvt_pk_bf16_f32 v69, v138, v139
    v_lshlrev_b32 v48, 16, v70
    v_and_b32 v49, 0xffff0000, v70
    v_pk_fma_f32 v[140:141], v[48:49], v[46:47], v[140:141]
    v_cvt_pk_bf16_f32 v70, v140, v141
    v_lshlrev_b32 v48, 16, v71
    v_and_b32 v49, 0xffff0000, v71
    v_pk_fma_f32 v[142:143], v[48:49], v[46:47], v[142:143]
    v_cvt_pk_bf16_f32 v71, v142, v143
    s_mov_b32 s47, 16384
    buffer_store_dwordx4 v[68:71], v63, s[16:19], s47 offen sc0 sc1
    s_waitcnt lgkmcnt(1)
    v_mov_b32 v46, v37
    v_mov_b32 v47, v37
    v_lshlrev_b32 v48, 16, v72
    v_and_b32 v49, 0xffff0000, v72
    v_pk_fma_f32 v[144:145], v[48:49], v[46:47], v[144:145]
    v_cvt_pk_bf16_f32 v72, v144, v145
    v_lshlrev_b32 v48, 16, v73
    v_and_b32 v49, 0xffff0000, v73
    v_pk_fma_f32 v[146:147], v[48:49], v[46:47], v[146:147]
    v_cvt_pk_bf16_f32 v73, v146, v147
    v_lshlrev_b32 v48, 16, v74
    v_and_b32 v49, 0xffff0000, v74
    v_pk_fma_f32 v[148:149], v[48:49], v[46:47], v[148:149]
    v_cvt_pk_bf16_f32 v74, v148, v149
    v_lshlrev_b32 v48, 16, v75
    v_and_b32 v49, 0xffff0000, v75
    v_pk_fma_f32 v[150:151], v[48:49], v[46:47], v[150:151]
    v_cvt_pk_bf16_f32 v75, v150, v151
    s_mov_b32 s47, 32768
    buffer_store_dwordx4 v[72:75], v63, s[16:19], s47 offen sc0 sc1
    s_waitcnt lgkmcnt(0)
    v_mov_b32 v46, v39
    v_mov_b32 v47, v39
    v_lshlrev_b32 v48, 16, v76
    v_and_b32 v49, 0xffff0000, v76
    v_pk_fma_f32 v[152:153], v[48:49], v[46:47], v[152:153]
    v_cvt_pk_bf16_f32 v76, v152, v153
    v_lshlrev_b32 v48, 16, v77
    v_and_b32 v49, 0xffff0000, v77
    v_pk_fma_f32 v[154:155], v[48:49], v[46:47], v[154:155]
    v_cvt_pk_bf16_f32 v77, v154, v155
    v_lshlrev_b32 v48, 16, v78
    v_and_b32 v49, 0xffff0000, v78
    v_pk_fma_f32 v[156:157], v[48:49], v[46:47], v[156:157]
    v_cvt_pk_bf16_f32 v78, v156, v157
    v_lshlrev_b32 v48, 16, v79
    v_and_b32 v49, 0xffff0000, v79
    v_pk_fma_f32 v[158:159], v[48:49], v[46:47], v[158:159]
    v_cvt_pk_bf16_f32 v79, v158, v159
    s_mov_b32 s47, 49152
    buffer_store_dwordx4 v[76:79], v63, s[16:19], s47 offen sc0 sc1
    s_endpgm
p2_ld_ypub:
    s_cmp_eq_u32 s35, 1
    s_cbranch_scc0 p2_ld_ypub_r
    s_waitcnt vmcnt(0)
    s_barrier
    s_cmp_eq_u32 s45, 3
    s_cbranch_scc0 p2_ld_ypub_n
    v_mov_b32 v29, s34
    buffer_store_dword v29, v28, s[52:55], 0 offen sc1
p2_ld_ypub_n:
    s_add_u32 m0, s43, s50
    s_nop 0
    buffer_load_dwordx4 v2, s[8:11], s40 offen offset:0 lds
    buffer_load_dwordx4 v3, s[8:11], s40 offen offset:1024 lds
    buffer_load_dwordx4 v4, s[8:11], s40 offen offset:2048 lds
    buffer_load_dwordx4 v5, s[8:11], s40 offen offset:3072 lds
    s_add_u32 m0, s43, s51
    s_nop 0
    buffer_load_dwordx4 v6, s[12:15], s41 offen offset:0 lds
    buffer_load_dwordx4 v7, s[12:15], s41 offen offset:1024 lds
    buffer_load_dwordx4 v8, s[12:15], s41 offen offset:2048 lds
    buffer_load_dwordx4 v9, s[12:15], s41 offen offset:3072 lds
    s_add_u32 s40, s40, 128
    s_add_u32 s41, s41, 131072
    s_add_u32 s43, s43, 32768
    s_cmp_ge_u32 s43, 131072
    s_cselect_b32 s43, 0, s43
    s_branch p2_ld_ypub_r2
f_cp:
    s_load_dwordx2 s[6:7], s[0:1], 64
    s_load_dwordx2 s[20:21], s[0:1], 72
    s_load_dwordx2 s[22:23], s[0:1], 88
    s_load_dwordx2 s[4:5], s[0:1], 104
    s_load_dwordx2 s[62:63], s[0:1], 96
    s_lshr_b32 s27, s2, 3
    s_bfe_u32 s67, s2, 0x10001
    s_bfe_u32 s28, s2, 0x10002
    s_lshl_b32 s28, s28, 3
    s_lshr_b32 s30, s27, 2
    s_add_u32 s28, s28, s30
    s_and_b32 s29, s2, 1
    s_lshl_b32 s29, s29, 2
    s_and_b32 s30, s27, 3
    s_add_u32 s29, s29, s30
    s_mul_i32 s40, s28, 950272
    s_mul_i32 s30, s67, 3584
    s_add_u32 s40, s40, s30
    s_mul_i32 s41, s29, 256
    s_mul_i32 s30, s67, 3670016
    s_add_u32 s41, s41, s30
    s_and_b32 s30, s2, 1
    s_mul_i32 s31, s30, 1792
    s_add_u32 s40, s40, s31
    s_mul_i32 s31, s30, 1835008
    s_add_u32 s41, s41, s31
    s_and_b32 s31, s45, 1
    s_lshl_b32 s31, s31, 6
    s_lshl_b32 s30, s28, 7
    s_add_u32 s30, s30, s31
    s_lshl_b32 s31, s67, 5
    s_add_u32 s30, s30, s31
    s_bfe_u32 s31, s45, 0x10001
    s_lshl_b32 s31, s31, 7
    s_lshl_b32 s66, s29, 8
    s_add_u32 s31, s31, s66
    s_and_b32 s46, s45, 1
    s_lshr_b32 s47, s45, 1
    v_and_b32 v8, 15, v1
    s_mul_i32 s48, s46, 8192
    v_lshlrev_b32 v8, 7, v8
    v_add_u32 v8, s48, v8
    v_lshrrev_b32 v9, 4, v1
    v_bfe_u32 v10, v1, 1, 3
    v_xor_b32 v9, v9, v10
    v_xor_b32 v11, 0, v9
    v_lshl_add_u32 v2, v11, 4, v8
    v_xor_b32 v11, 4, v9
    v_lshl_add_u32 v3, v11, 4, v8
    v_bfe_u32 v8, v1, 2, 2
    v_lshrrev_b32 v9, 4, v1
    v_lshl_add_u32 v10, v9, 3, v8
    v_lshlrev_b32 v10, 8, v10
    v_add_u32 v10, 16384, v10
    v_and_b32 v11, 1, v1
    v_lshl_add_u32 v10, v11, 3, v10
    v_bfe_u32 v11, v1, 1, 1
    s_mul_i32 s48, s47, 8
    v_add_u32 v11, s48, v11
    v_lshlrev_b32 v8, 2, v8
    v_and_b32 v9, 1, v9
    v_lshlrev_b32 v9, 1, v9
    v_xor_b32 v8, v8, v9
    v_add_u32 v12, 0, v11
    v_xor_b32 v12, v12, v8
    v_lshl_add_u32 v4, v12, 4, v10
    v_add_u32 v12, 2, v11
    v_xor_b32 v12, v12, v8
    v_lshl_add_u32 v5, v12, 4, v10
    v_add_u32 v12, 4, v11
    v_xor_b32 v12, v12, v8
    v_lshl_add_u32 v6, v12, 4, v10
    v_add_u32 v12, 6, v11
    v_xor_b32 v12, v12, v8
    v_lshl_add_u32 v7, v12, 4, v10
    s_mov_b32 s52, 4294868992
    s_mov_b32 s53, 32768
    v_mov_b32 v128, 0
    v_mov_b32 v129, 0
    v_mov_b32 v130, 0
    v_mov_b32 v131, 0
    v_mov_b32 v132, 0
    v_mov_b32 v133, 0
    v_mov_b32 v134, 0
    v_mov_b32 v135, 0
    v_mov_b32 v136, 0
    v_mov_b32 v137, 0
    v_mov_b32 v138, 0
    v_mov_b32 v139, 0
    v_mov_b32 v140, 0
    v_mov_b32 v141, 0
    v_mov_b32 v142, 0
    v_mov_b32 v143, 0
    v_mov_b32 v144, 0
    v_mov_b32 v145, 0
    v_mov_b32 v146, 0
    v_mov_b32 v147, 0
    v_mov_b32 v148, 0
    v_mov_b32 v149, 0
    v_mov_b32 v150, 0
    v_mov_b32 v151, 0
    v_mov_b32 v152, 0
    v_mov_b32 v153, 0
    v_mov_b32 v154, 0
    v_mov_b32 v155, 0
    v_mov_b32 v156, 0
    v_mov_b32 v157, 0
    v_mov_b32 v158, 0
    v_mov_b32 v159, 0
    v_mov_b32 v160, 0
    v_mov_b32 v161, 0
    v_mov_b32 v162, 0
    v_mov_b32 v163, 0
    v_mov_b32 v164, 0
    v_mov_b32 v165, 0
    v_mov_b32 v166, 0
    v_mov_b32 v167, 0
    v_mov_b32 v168, 0
    v_mov_b32 v169, 0
    v_mov_b32 v170, 0
    v_mov_b32 v171, 0
    v_mov_b32 v172, 0
    v_mov_b32 v173, 0
    v_mov_b32 v174, 0
    v_mov_b32 v175, 0
    v_mov_b32 v176, 0
    v_mov_b32 v177, 0
    v_mov_b32 v178, 0
    v_mov_b32 v179, 0
    v_mov_b32 v180, 0
    v_mov_b32 v181, 0
    v_mov_b32 v182, 0
    v_mov_b32 v183, 0
    v_mov_b32 v184, 0
    v_mov_b32 v185, 0
    v_mov_b32 v186, 0
    v_mov_b32 v187, 0
    v_mov_b32 v188, 0
    v_mov_b32 v189, 0
    v_mov_b32 v190, 0
    v_mov_b32 v191, 0
    s_lshl_b32 s66, s45, 12
    v_and_b32 v18, 15, v1
    v_lshlrev_b32 v19, 7, v18
    v_add_u32 v19, s66, v19
    v_bfe_u32 v24, v1, 4, 1
    v_lshl_add_u32 v19, v24, 3, v19
    v_and_b32 v18, 7, v18
    v_lshrrev_b32 v24, 5, v1
    v_add_u32 v25, 0, v24
    v_xor_b32 v25, v25, v18
    v_lshl_add_u32 v20, v25, 4, v19
    v_add_u32 v25, 2, v24
    v_xor_b32 v25, v25, v18
    v_lshl_add_u32 v21, v25, 4, v19
    v_add_u32 v25, 4, v24
    v_xor_b32 v25, v25, v18
    v_lshl_add_u32 v22, v25, 4, v19
    v_add_u32 v25, 6, v24
    v_xor_b32 v25, v25, v18
    v_lshl_add_u32 v23, v25, 4, v19
    s_waitcnt lgkmcnt(0)
    s_mov_b32 s84, s62
    s_and_b32 s85, s63, 0xffff
    s_mov_b32 s86, 256
    s_mov_b32 s87, 0x00020000
    v_mov_b32 v27, 0
    buffer_load_dword v26, v27, s[84:87], 0 offen
    s_mov_b32 s6, s4
    s_mov_b32 s7, s5
    s_add_u32 s6, s6, 41943040
    s_addc_u32 s7, s7, 0
    s_mov_b32 s56, s6
    s_and_b32 s57, s7, 0xffff
    s_mov_b32 s58, 4194304
    s_mov_b32 s59, 0x00020000
    s_mov_b32 s6, s4
    s_mov_b32 s7, s5
    s_add_u32 s6, s6, 34603008
    s_addc_u32 s7, s7, 0
    s_mov_b32 s8, s6
    s_and_b32 s9, s7, 0xffff
    s_mov_b32 s10, 131072
    s_mov_b32 s11, 0x00020000
    s_mov_b32 s6, s4
    s_mov_b32 s7, s5
    s_add_u32 s6, s6, 36700160
    s_addc_u32 s7, s7, 0
    s_mov_b32 s60, s6
    s_and_b32 s61, s7, 0xffff
    s_mov_b32 s62, 131072
    s_mov_b32 s63, 0x00020000
    v_mov_b32 v25, 0x7ffffff0
    s_lshr_b32 s64, s28, 1
    s_and_b32 s65, s2, 3
    s_lshl_b32 s66, s64, 2
    s_add_u32 s66, s66, s65
    s_lshl_b32 s66, s66, 7
    s_add_u32 s66, s66, 8192
    s_lshl_b32 s64, s64, 9
    s_mul_i32 s65, s65, 112
    s_add_u32 s64, s64, s65
    v_lshlrev_b32 v28, 2, v1
    v_add_u32 v30, s64, v28
    v_add_u32 v29, s66, v28
    v_cmp_gt_u32 vcc, 28, v1
    s_nop 1
    v_cndmask_b32 v30, v25, v30, vcc
    v_cndmask_b32 v29, v25, v29, vcc
    s_barrier
    s_waitcnt vmcnt(0)
    s_mov_b32 s69, 0x8000
np_71:
    v_readfirstlane_b32 s68, v26
    s_sub_u32 s69, s69, 1
    s_cbranch_scc1 npx_72
    s_cmp_lg_u32 s68, 0
    s_cbranch_scc1 npx_72
    buffer_load_dword v26, v27, s[84:87], 0 offen sc1
    s_waitcnt vmcnt(0)
    s_branch np_71
npx_72:
    s_cmp_eq_u32 s45, 0
    s_cbranch_scc0 hq_74
    s_mov_b32 s69, 0x8000
    s_getreg_b32 s65, hwreg(HW_REG_XCC_ID)
    s_add_u32 s65, s65, 1
    s_lshl_b32 s65, s65, 1
    s_add_u32 s65, s65, s68
hl_73:
    buffer_load_dword v31, v29, s[60:63], 0 offen sc0
    s_waitcnt vmcnt(0)
    v_cmp_ne_u32 vcc, s65, v31
    s_nop 4
    s_and_b32 s64, vcc_lo, 0xfffffff
    s_cbranch_scc0 hq_74
    s_sleep 1
    buffer_load_dword v31, v29, s[60:63], 0 offen sc0
    s_waitcnt vmcnt(0)
    v_cmp_ne_u32 vcc, s65, v31
    s_nop 4
    s_and_b32 s64, vcc_lo, 0xfffffff
    s_cbranch_scc0 hq_74
    s_sleep 1
    buffer_load_dword v31, v29, s[60:63], 0 offen sc0
    s_waitcnt vmcnt(0)
    v_cmp_ne_u32 vcc, s65, v31
    s_nop 4
    s_and_b32 s64, vcc_lo, 0xfffffff
    s_cbranch_scc0 hq_74
    s_sleep 1
    buffer_load_dword v31, v29, s[60:63], 0 offen sc0
    s_waitcnt vmcnt(0)
    v_cmp_ne_u32 vcc, s65, v31
    s_nop 4
    s_and_b32 s64, vcc_lo, 0xfffffff
    s_cbranch_scc0 hq_74
    s_sleep 1
    buffer_load_dword v31, v29, s[60:63], 0 offen sc0
    s_waitcnt vmcnt(0)
    v_cmp_ne_u32 vcc, s65, v31
    s_nop 4
    s_and_b32 s64, vcc_lo, 0xfffffff
    s_cbranch_scc0 hq_74
    s_sleep 1
    buffer_load_dword v31, v29, s[60:63], 0 offen sc0
    s_waitcnt vmcnt(0)
    v_cmp_ne_u32 vcc, s65, v31
    s_nop 4
    s_and_b32 s64, vcc_lo, 0xfffffff
    s_cbranch_scc0 hq_74
    s_sleep 1
    buffer_load_dword v31, v30, s[60:63], 0 offen sc1
    s_waitcnt vmcnt(0)
    v_cmp_ne_u32 vcc, s68, v31
    s_nop 4
    s_and_b32 s64, vcc_lo, 0xfffffff
    s_cbranch_scc0 hq_74
    s_sub_u32 s69, s69, 1
    s_cbranch_scc1 hq_74
    s_branch hl_73
hq_74:
    s_barrier
    s_barrier
    ds_read_b64_tr_b16 v[32:33], v4 offset:0
    ds_read_b64_tr_b16 v[34:35], v4 offset:1024
    ds_read_b128 v[48:51], v2 offset:0
    ds_read_b128 v[52:55], v2 offset:2048
    ds_read_b128 v[56:59], v2 offset:4096
    ds_read_b128 v[60:63], v2 offset:6144
    ds_read_b64_tr_b16 v[36:37], v5 offset:0
    ds_read_b64_tr_b16 v[38:39], v5 offset:1024
    ds_read_b64_tr_b16 v[40:41], v6 offset:0
    ds_read_b64_tr_b16 v[42:43], v6 offset:1024
    ds_read_b64_tr_b16 v[44:45], v7 offset:0
    ds_read_b64_tr_b16 v[46:47], v7 offset:1024
    s_mov_b32 s44, 28
    s_mov_b32 s49, 0
.p2align 6
p2_c_loop:
    s_waitcnt lgkmcnt(0)
    v_mfma_f32_16x16x32_bf16 v[128:131], v[32:35], v[48:51], v[128:131]
    ds_read_b64_tr_b16 v[64:65], v4 offset:8192
    v_mfma_f32_16x16x32_bf16 v[132:135], v[32:35], v[52:55], v[132:135]
    ds_read_b64_tr_b16 v[66:67], v4 offset:9216
    v_mfma_f32_16x16x32_bf16 v[136:139], v[32:35], v[56:59], v[136:139]
    ds_read_b128 v[80:83], v3 offset:0
    v_mfma_f32_16x16x32_bf16 v[140:143], v[32:35], v[60:63], v[140:143]
    ds_read_b128 v[84:87], v3 offset:2048
    v_mfma_f32_16x16x32_bf16 v[144:147], v[36:39], v[48:51], v[144:147]
    ds_read_b128 v[88:91], v3 offset:4096
    v_mfma_f32_16x16x32_bf16 v[148:151], v[36:39], v[52:55], v[148:151]
    ds_read_b128 v[92:95], v3 offset:6144
    v_mfma_f32_16x16x32_bf16 v[152:155], v[36:39], v[56:59], v[152:155]
    ds_read_b64_tr_b16 v[68:69], v5 offset:8192
    v_mfma_f32_16x16x32_bf16 v[156:159], v[36:39], v[60:63], v[156:159]
    ds_read_b64_tr_b16 v[70:71], v5 offset:9216
    v_mfma_f32_16x16x32_bf16 v[160:163], v[40:43], v[48:51], v[160:163]
    ds_read_b64_tr_b16 v[72:73], v6 offset:8192
    v_mfma_f32_16x16x32_bf16 v[164:167], v[40:43], v[52:55], v[164:167]
    ds_read_b64_tr_b16 v[74:75], v6 offset:9216
    v_mfma_f32_16x16x32_bf16 v[168:171], v[40:43], v[56:59], v[168:171]
    ds_read_b64_tr_b16 v[76:77], v7 offset:8192
    v_mfma_f32_16x16x32_bf16 v[172:175], v[40:43], v[60:63], v[172:175]
    ds_read_b64_tr_b16 v[78:79], v7 offset:9216
    v_mfma_f32_16x16x32_bf16 v[176:179], v[44:47], v[48:51], v[176:179]
    v_mfma_f32_16x16x32_bf16 v[180:183], v[44:47], v[52:55], v[180:183]
    v_mfma_f32_16x16x32_bf16 v[184:187], v[44:47], v[56:59], v[184:187]
    v_mfma_f32_16x16x32_bf16 v[188:191], v[44:47], v[60:63], v[188:191]
    s_waitcnt lgkmcnt(0)
    s_barrier
    v_mfma_f32_16x16x32_bf16 v[128:131], v[64:67], v[80:83], v[128:131]
    s_add_u32 s49, s49, 32768
    s_cmp_ge_u32 s49, 131072
    v_mfma_f32_16x16x32_bf16 v[132:135], v[64:67], v[84:87], v[132:135]
    s_cselect_b32 s48, s52, s53
    s_cselect_b32 s49, 0, s49
    v_mfma_f32_16x16x32_bf16 v[136:139], v[64:67], v[88:91], v[136:139]
    v_add_u32 v2, s48, v2
    v_mfma_f32_16x16x32_bf16 v[140:143], v[64:67], v[92:95], v[140:143]
    v_add_u32 v3, s48, v3
    v_mfma_f32_16x16x32_bf16 v[144:147], v[68:71], v[80:83], v[144:147]
    v_add_u32 v4, s48, v4
    v_mfma_f32_16x16x32_bf16 v[148:151], v[68:71], v[84:87], v[148:151]
    v_add_u32 v5, s48, v5
    v_mfma_f32_16x16x32_bf16 v[152:155], v[68:71], v[88:91], v[152:155]
    v_add_u32 v6, s48, v6
    v_mfma_f32_16x16x32_bf16 v[156:159], v[68:71], v[92:95], v[156:159]
    v_add_u32 v7, s48, v7
    v_mfma_f32_16x16x32_bf16 v[160:163], v[72:75], v[80:83], v[160:163]
    ds_read_b64_tr_b16 v[32:33], v4 offset:0
    v_mfma_f32_16x16x32_bf16 v[164:167], v[72:75], v[84:87], v[164:167]
    ds_read_b64_tr_b16 v[34:35], v4 offset:1024
    v_mfma_f32_16x16x32_bf16 v[168:171], v[72:75], v[88:91], v[168:171]
    ds_read_b128 v[48:51], v2 offset:0
    v_mfma_f32_16x16x32_bf16 v[172:175], v[72:75], v[92:95], v[172:175]
    ds_read_b128 v[52:55], v2 offset:2048
    v_mfma_f32_16x16x32_bf16 v[176:179], v[76:79], v[80:83], v[176:179]
    ds_read_b128 v[56:59], v2 offset:4096
    v_mfma_f32_16x16x32_bf16 v[180:183], v[76:79], v[84:87], v[180:183]
    ds_read_b128 v[60:63], v2 offset:6144
    v_mfma_f32_16x16x32_bf16 v[184:187], v[76:79], v[88:91], v[184:187]
    ds_read_b64_tr_b16 v[36:37], v5 offset:0
    v_mfma_f32_16x16x32_bf16 v[188:191], v[76:79], v[92:95], v[188:191]
    ds_read_b64_tr_b16 v[38:39], v5 offset:1024
    ds_read_b64_tr_b16 v[40:41], v6 offset:0
    ds_read_b64_tr_b16 v[42:43], v6 offset:1024
    ds_read_b64_tr_b16 v[44:45], v7 offset:0
    ds_read_b64_tr_b16 v[46:47], v7 offset:1024
    s_sub_u32 s44, s44, 1
    s_cmp_lg_u32 s44, 0
    s_cbranch_scc1 p2_c_loop
    s_waitcnt lgkmcnt(0)
    s_nop 7
    s_nop 7
    v_lshlrev_b32 v8, 4, v1
    s_xor_b32 s61, s2, 2
    s_lshl_b32 s60, s61, 14
    s_lshl_b32 s62, s45, 12
    s_add_u32 s60, s60, s62
    v_cvt_pk_bf16_f32 v32, v136, v137
    v_cvt_pk_bf16_f32 v33, v138, v139
    v_cvt_pk_bf16_f32 v34, v140, v141
    v_cvt_pk_bf16_f32 v35, v142, v143
    buffer_store_dwordx4 v[32:35], v8, s[56:59], s60 offen offset:0 sc1
    v_cvt_pk_bf16_f32 v36, v152, v153
    v_cvt_pk_bf16_f32 v37, v154, v155
    v_cvt_pk_bf16_f32 v38, v156, v157
    v_cvt_pk_bf16_f32 v39, v158, v159
    buffer_store_dwordx4 v[36:39], v8, s[56:59], s60 offen offset:1024 sc1
    v_cvt_pk_bf16_f32 v40, v168, v169
    v_cvt_pk_bf16_f32 v41, v170, v171
    v_cvt_pk_bf16_f32 v42, v172, v173
    v_cvt_pk_bf16_f32 v43, v174, v175
    buffer_store_dwordx4 v[40:43], v8, s[56:59], s60 offen offset:2048 sc1
    v_cvt_pk_bf16_f32 v44, v184, v185
    v_cvt_pk_bf16_f32 v45, v186, v187
    v_cvt_pk_bf16_f32 v46, v188, v189
    v_cvt_pk_bf16_f32 v47, v190, v191
    buffer_store_dwordx4 v[44:47], v8, s[56:59], s60 offen offset:3072 sc1
    s_waitcnt vmcnt(0)
    s_barrier
    s_cmp_eq_u32 s45, 0
    s_cbranch_scc0 p2_waitb
    s_lshl_b32 s62, s2, 7
    v_mov_b32 v12, s62
    v_mov_b32 v13, s68
    buffer_store_dword v13, v12, s[8:11], 0 offen sc1
    s_lshl_b32 s62, s61, 7
    v_mov_b32 v12, s62
    s_mov_b32 s69, 0x20000
p2_poll:
    buffer_load_dword v13, v12, s[8:11], 0 offen sc1
    s_waitcnt vmcnt(0)
    v_readfirstlane_b32 s62, v13
    s_sub_u32 s69, s69, 1
    s_cbranch_scc1 p2_waitb
    s_cmp_eq_u32 s62, s68
    s_cbranch_scc0 p2_poll
p2_waitb:
    s_barrier
    s_lshl_b32 s60, s2, 14
    s_lshl_b32 s62, s45, 12
    s_add_u32 s60, s60, s62
    buffer_load_dwordx4 v[32:35], v8, s[56:59], s60 offen offset:0 sc1
    buffer_load_dwordx4 v[36:39], v8, s[56:59], s60 offen offset:1024 sc1
    buffer_load_dwordx4 v[40:43], v8, s[56:59], s60 offen offset:2048 sc1
    buffer_load_dwordx4 v[44:47], v8, s[56:59], s60 offen offset:3072 sc1
    s_waitcnt vmcnt(3)
    v_lshlrev_b32 v10, 16, v32
    v_and_b32 v11, 0xffff0000, v32
    v_pk_add_f32 v[128:129], v[128:129], v[10:11]
    v_lshlrev_b32 v10, 16, v33
    v_and_b32 v11, 0xffff0000, v33
    v_pk_add_f32 v[130:131], v[130:131], v[10:11]
    v_cvt_pk_bf16_f32 v48, v128, v129
    v_cvt_pk_bf16_f32 v49, v130, v131
    ds_write_b64 v20, v[48:49] offset:0
    v_lshlrev_b32 v10, 16, v34
    v_and_b32 v11, 0xffff0000, v34
    v_pk_add_f32 v[132:133], v[132:133], v[10:11]
    v_lshlrev_b32 v10, 16, v35
    v_and_b32 v11, 0xffff0000, v35
    v_pk_add_f32 v[134:135], v[134:135], v[10:11]
    v_cvt_pk_bf16_f32 v50, v132, v133
    v_cvt_pk_bf16_f32 v51, v134, v135
    ds_write_b64 v20, v[50:51] offset:2048
    s_waitcnt vmcnt(2)
    v_lshlrev_b32 v10, 16, v36
    v_and_b32 v11, 0xffff0000, v36
    v_pk_add_f32 v[144:145], v[144:145], v[10:11]
    v_lshlrev_b32 v10, 16, v37
    v_and_b32 v11, 0xffff0000, v37
    v_pk_add_f32 v[146:147], v[146:147], v[10:11]
    v_cvt_pk_bf16_f32 v52, v144, v145
    v_cvt_pk_bf16_f32 v53, v146, v147
    ds_write_b64 v21, v[52:53] offset:0
    v_lshlrev_b32 v10, 16, v38
    v_and_b32 v11, 0xffff0000, v38
    v_pk_add_f32 v[148:149], v[148:149], v[10:11]
    v_lshlrev_b32 v10, 16, v39
    v_and_b32 v11, 0xffff0000, v39
    v_pk_add_f32 v[150:151], v[150:151], v[10:11]
    v_cvt_pk_bf16_f32 v54, v148, v149
    v_cvt_pk_bf16_f32 v55, v150, v151
    ds_write_b64 v21, v[54:55] offset:2048
    s_waitcnt vmcnt(1)
    v_lshlrev_b32 v10, 16, v40
    v_and_b32 v11, 0xffff0000, v40
    v_pk_add_f32 v[160:161], v[160:161], v[10:11]
    v_lshlrev_b32 v10, 16, v41
    v_and_b32 v11, 0xffff0000, v41
    v_pk_add_f32 v[162:163], v[162:163], v[10:11]
    v_cvt_pk_bf16_f32 v56, v160, v161
    v_cvt_pk_bf16_f32 v57, v162, v163
    ds_write_b64 v22, v[56:57] offset:0
    v_lshlrev_b32 v10, 16, v42
    v_and_b32 v11, 0xffff0000, v42
    v_pk_add_f32 v[164:165], v[164:165], v[10:11]
    v_lshlrev_b32 v10, 16, v43
    v_and_b32 v11, 0xffff0000, v43
    v_pk_add_f32 v[166:167], v[166:167], v[10:11]
    v_cvt_pk_bf16_f32 v58, v164, v165
    v_cvt_pk_bf16_f32 v59, v166, v167
    ds_write_b64 v22, v[58:59] offset:2048
    s_waitcnt vmcnt(0)
    v_lshlrev_b32 v10, 16, v44
    v_and_b32 v11, 0xffff0000, v44
    v_pk_add_f32 v[176:177], v[176:177], v[10:11]
    v_lshlrev_b32 v10, 16, v45
    v_and_b32 v11, 0xffff0000, v45
    v_pk_add_f32 v[178:179], v[178:179], v[10:11]
    v_cvt_pk_bf16_f32 v60, v176, v177
    v_cvt_pk_bf16_f32 v61, v178, v179
    ds_write_b64 v23, v[60:61] offset:0
    v_lshlrev_b32 v10, 16, v46
    v_and_b32 v11, 0xffff0000, v46
    v_pk_add_f32 v[180:181], v[180:181], v[10:11]
    v_lshlrev_b32 v10, 16, v47
    v_and_b32 v11, 0xffff0000, v47
    v_pk_add_f32 v[182:183], v[182:183], v[10:11]
    v_cvt_pk_bf16_f32 v62, v180, v181
    v_cvt_pk_bf16_f32 v63, v182, v183
    ds_write_b64 v23, v[62:63] offset:2048
    s_waitcnt lgkmcnt(0)
    s_barrier
p2_end:
    s_endpgm
.section .rodata,"a"
.p2align 6
.amdhsa_kernel f_kernel
  .amdhsa_next_free_vgpr 256
  .amdhsa_next_free_sgpr 96
  .amdhsa_accum_offset 256
  .amdhsa_group_segment_fixed_size 0
  .amdhsa_kernarg_size 112
  .amdhsa_user_sgpr_count 2
  .amdhsa_user_sgpr_kernarg_segment_ptr 1
  .amdhsa_system_sgpr_workgroup_id_x 1
  .amdhsa_float_denorm_mode_32 3
  .amdhsa_float_denorm_mode_16_64 3
.end_amdhsa_kernel
```
